```python
import torch

def _softmax(x, axis=-1):
    return torch.softmax(x, dim=axis)
def _gelu(x):
    return torch.nn.functional.gelu(x, approximate="tanh")
def _silu(x):
    return torch.nn.functional.silu(x)
def _sigmoid(x):
    return torch.sigmoid(x)
def _layernorm(x, axis=-1, eps=1e-5):
    m = x.mean(dim=axis, keepdim=True)
    v = x.var(dim=axis, keepdim=True, unbiased=False)
    return (x - m) / torch.sqrt(v + eps)
def _scatter_add(tgt, idx, src, axis=0):
    return tgt.clone().index_add_(axis, idx, src)
def _segment_sum(src, seg, n):
    out = torch.zeros((n,) + src.shape[1:], dtype=src.dtype)
    return out.index_add_(0, seg, src)
def _pad(x, pw):
    flat = tuple(v for pair in reversed(pw) for v in pair)
    return torch.nn.functional.pad(x, flat)

kernel_name = 'parallel_sum__gqa_block_cached__mixer_channel_mlp__decode'

def setup_inputs():

    _w = (lambda a: (lambda t: t.to(torch.bfloat16) if t.is_floating_point() else t)(torch.as_tensor(a)))
    def _A_setup():
        B, Sq, D = 1, 1, 640
        Hq, Hkv, Sk, Dh = 32, 32, 16384, 128
        assert Hq % Hkv == 0, (Hq, Hkv)
        return {
            "x": _w((lambda *s: torch.randn(*s, dtype=torch.bfloat16) * 0.05)(B, Sq, D)),
            "k_cache": _w((lambda *s: torch.randn(*s, dtype=torch.bfloat16) * 3.2)(B, Hkv, Sk, Dh)),
            "v_cache": _w((lambda *s: torch.randn(*s, dtype=torch.bfloat16) * 0.4)(B, Hkv, Sk, Dh)),
            "wq": _w((lambda *s: torch.randn(*s, dtype=torch.bfloat16) * 3.2)(D, Hq * Dh) * (D ** -0.5)),
            "wo": _w((lambda *s: torch.randn(*s, dtype=torch.bfloat16) * 0.4)(Hq * Dh, D) * ((Hq * Dh) ** -0.5)),
        }
    _A_in = _A_setup()

    def _B_setup():
        B, S, D, F = 1, 1, 640, 1728
        return {
            "x": _w((lambda *s: torch.randn(*s, dtype=torch.bfloat16) * 0.05)(B, S, D)),
            "w1": _w((lambda *s: torch.randn(*s, dtype=torch.bfloat16) * 3.2)(D, F) * (D ** -0.5)),
            "b1": _w((lambda *s: torch.randn(*s, dtype=torch.bfloat16) * 0.8)(F)),
            "w2": _w((lambda *s: torch.randn(*s, dtype=torch.bfloat16) * 0.1)(F, D) * (F ** -0.5)),
            "b2": _w((lambda *s: torch.randn(*s, dtype=torch.bfloat16) * 0.1)(D)),
        }
    _B_in = _B_setup()

    return {
        "A_x": _A_in["x"],
        "A_k_cache": _A_in["k_cache"],
        "A_v_cache": _A_in["v_cache"],
        "A_wq": _A_in["wq"],
        "A_wo": _A_in["wo"],
        "B_x": _B_in["x"],
        "B_w1": _B_in["w1"],
        "B_b1": _B_in["b1"],
        "B_w2": _B_in["w2"],
        "B_b2": _B_in["b2"],
    }

def reference(A_x, A_k_cache, A_v_cache, A_wq, A_wo, B_x, B_w1, B_b1, B_w2, B_b2):
    def _A_ref(x, k_cache, v_cache, wq, wo):
        B, Sq, D = x.shape
        Hq, Dh = 32, 128
        Hkv = k_cache.shape[1]
        rep = Hq // Hkv
        q = (lambda x, *d: x.permute(*d))((x @ wq).reshape(B, Sq, Hq, Dh), 0, 2, 1, 3)
        k = (lambda x, n, axis: torch.repeat_interleave(x, n, dim=axis))(k_cache, rep, axis=1)
        v = (lambda x, n, axis: torch.repeat_interleave(x, n, dim=axis))(v_cache, rep, axis=1)
        scores = torch.einsum("bhqd,bhkd->bhqk", q, k) * (Dh ** -0.5)
        p = _softmax(scores, axis=-1)
        o = torch.einsum("bhqk,bhkd->bhqd", p, v)
        return (lambda x, *d: x.permute(*d))(o, 0, 2, 1, 3).reshape(B, Sq, Hq * Dh) @ wo

    def _B_ref(x, w1, b1, w2, b2):
        y = _layernorm(x, axis=-1)
        h = _gelu(torch.einsum("bsd,df->bsf", y, w1) + b1)
        return torch.einsum("bsf,fd->bsd", h, w2) + b2

    x = A_x
    xn = _layernorm(x, axis=-1)
    return x + _A_ref(xn, A_k_cache, A_v_cache, A_wq, A_wo) + _B_ref(xn, B_w1, B_b1, B_w2, B_b2)
```

```asm
; @launch grid=(256,1,1) block=(512,1,1) lds=30976
.amdgcn_target "amdgcn-amd-amdhsa--gfx950"
.text
.globl parallel_sum__gqa_block_cached__mixer_channel_mlp__decode_kernel
.p2align 8
.type parallel_sum__gqa_block_cached__mixer_channel_mlp__decode_kernel,@function
parallel_sum__gqa_block_cached__mixer_channel_mlp__decode_kernel:
  s_lshr_b32 s75, s2, 3
  s_cmp_ge_u32 s75, 32
  s_cbranch_scc1 L_end
  s_load_dwordx16 s[44:59], s[0:1], 0
  v_lshrrev_b32 v228, 6, v0
  s_and_b32 s3, s2, 7
  v_readfirstlane_b32 s70, v228
  s_lshl_b32 s71, s3, 5
  s_add_u32 s71, s71, s75
  v_and_b32 v8, 15, v0
  v_and_b32 v229, 48, v0
  v_lshl_or_b32 v1, v8, 8, v229
  s_lshl_b32 s77, s71, 19
  s_lshl_b32 s78, s70, 12
  s_cmp_lt_u32 s70, 4
  s_cbranch_scc1 L_P
  s_add_u32 s77, s77, s78
  v_lshlrev_b32 v2, 6, v229
  v_lshl_or_b32 v2, v8, 4, v2
  s_waitcnt lgkmcnt(0)
  s_add_u32 s92, s46, s77
  s_addc_u32 s93, s47, 0
  global_load_dwordx4 v[16:19], v1, s[92:93] offset:0 nt
  global_load_dwordx4 v[20:23], v1, s[92:93] offset:64 nt
  global_load_dwordx4 v[24:27], v1, s[92:93] offset:128 nt
  global_load_dwordx4 v[28:31], v1, s[92:93] offset:192 nt
  s_add_u32 s92, s48, s77
  s_addc_u32 s93, s49, 0
  global_load_dwordx4 v[32:35], v2, s[92:93] offset:0 nt
  global_load_dwordx4 v[36:39], v2, s[92:93] offset:256 nt
  global_load_dwordx4 v[40:43], v2, s[92:93] offset:512 nt
  global_load_dwordx4 v[44:47], v2, s[92:93] offset:768 nt
L_S2:
  s_load_dwordx8 s[60:67], s[0:1], 64
  s_load_dwordx2 s[68:69], s[0:1], 96
  s_add_u32 s4, s46, s77
  s_addc_u32 s5, s47, 0
  s_and_b32 s5, s5, 0xffff
  s_mov_b32 s6, 495616
  s_mov_b32 s7, 0x20000
  s_add_u32 s8, s48, s77
  s_addc_u32 s9, s49, 0
  s_and_b32 s9, s9, 0xffff
  s_mov_b32 s10, 495616
  s_mov_b32 s11, 0x20000
  s_mov_b32 s74, 0
  v_and_b32 v0, 63, v0
  v_lshrrev_b32 v9, 4, v0
  v_lshlrev_b32 v3, 4, v0
  s_lshr_b32 s72, s71, 3
  s_and_b32 s73, s71, 7
  s_add_u32 s74, s74, 32768
  buffer_load_dwordx4 v[48:51], v1, s[4:7], s74 offen offset:0 nt
  buffer_load_dwordx4 v[52:55], v1, s[4:7], s74 offen offset:64 nt
  buffer_load_dwordx4 v[56:59], v1, s[4:7], s74 offen offset:128 nt
  buffer_load_dwordx4 v[60:63], v1, s[4:7], s74 offen offset:192 nt
  buffer_load_dwordx4 v[64:67], v2, s[8:11], s74 offen offset:0 nt
  buffer_load_dwordx4 v[68:71], v2, s[8:11], s74 offen offset:256 nt
  buffer_load_dwordx4 v[72:75], v2, s[8:11], s74 offen offset:512 nt
  buffer_load_dwordx4 v[76:79], v2, s[8:11], s74 offen offset:768 nt
  s_waitcnt lgkmcnt(0)
  s_load_dword s3, s[68:69], 0
  s_add_u32 s74, s74, 32768
  buffer_load_dwordx4 v[80:83], v1, s[4:7], s74 offen offset:0 nt
  buffer_load_dwordx4 v[84:87], v1, s[4:7], s74 offen offset:64 nt
  buffer_load_dwordx4 v[88:91], v1, s[4:7], s74 offen offset:128 nt
  buffer_load_dwordx4 v[92:95], v1, s[4:7], s74 offen offset:192 nt
  buffer_load_dwordx4 v[96:99], v2, s[8:11], s74 offen offset:0 nt
  buffer_load_dwordx4 v[100:103], v2, s[8:11], s74 offen offset:256 nt
  buffer_load_dwordx4 v[104:107], v2, s[8:11], s74 offen offset:512 nt
  buffer_load_dwordx4 v[108:111], v2, s[8:11], s74 offen offset:768 nt
  s_add_u32 s74, s74, 32768
  buffer_load_dwordx4 v[112:115], v1, s[4:7], s74 offen offset:0 nt
  buffer_load_dwordx4 v[116:119], v1, s[4:7], s74 offen offset:64 nt
  buffer_load_dwordx4 v[120:123], v1, s[4:7], s74 offen offset:128 nt
  buffer_load_dwordx4 v[124:127], v1, s[4:7], s74 offen offset:192 nt
  buffer_load_dwordx4 v[128:131], v2, s[8:11], s74 offen offset:0 nt
  buffer_load_dwordx4 v[132:135], v2, s[8:11], s74 offen offset:256 nt
  buffer_load_dwordx4 v[136:139], v2, s[8:11], s74 offen offset:512 nt
  buffer_load_dwordx4 v[140:143], v2, s[8:11], s74 offen offset:768 nt
  s_add_u32 s74, s74, 32768
  buffer_load_dwordx4 v[144:147], v1, s[4:7], s74 offen offset:0 nt
  buffer_load_dwordx4 v[148:151], v1, s[4:7], s74 offen offset:64 nt
  buffer_load_dwordx4 v[152:155], v1, s[4:7], s74 offen offset:128 nt
  buffer_load_dwordx4 v[156:159], v1, s[4:7], s74 offen offset:192 nt
  buffer_load_dwordx4 v[160:163], v2, s[8:11], s74 offen offset:0 nt
  buffer_load_dwordx4 v[164:167], v2, s[8:11], s74 offen offset:256 nt
  buffer_load_dwordx4 v[168:171], v2, s[8:11], s74 offen offset:512 nt
  buffer_load_dwordx4 v[172:175], v2, s[8:11], s74 offen offset:768 nt
  s_and_b32 s81, s73, 3
  s_lshr_b32 s82, s73, 2
  s_mov_b32 s28, s68
  s_and_b32 s29, s69, 0xffff
  s_mov_b32 s30, 8388608
  s_mov_b32 s31, 0x20000
  s_mov_b32 s96, 0x05040100
  s_mov_b32 s97, 0x07060302
  s_mov_b32 s98, 0x3fb8aa3b
  s_mov_b32 s99, 0x3db504f3
  s_mov_b32 s86, 0
  s_mov_b32 s87, -1
  s_mov_b32 s84, 0xffff0000
  s_mov_b32 s85, 0xffff0000
  s_mul_i32 s94, s72, 34816
  s_lshl_b32 s75, s73, 8
  s_lshl_b32 s76, s70, 6
  s_add_u32 s94, s94, s75
  s_add_u32 s94, s94, s76
  s_add_u32 s94, s94, 262912
  v_mul_u32_u24 v5, 2176, v8
  v_lshl_add_u32 v5, v9, 4, v5
  v_mov_b32 v216, 0
  v_mov_b32 v217, 0
  v_mov_b32 v218, 0
  v_mov_b32 v219, 0
  v_mov_b32 v220, 0
  v_mov_b32 v221, 0
  v_mov_b32 v222, 0
  v_mov_b32 v223, 0
  v_mov_b32 v4, 0
  v_mov_b32 v6, 0xff7fffff
  s_waitcnt lgkmcnt(0)
  s_add_u32 s3, s3, 0x9e3779b9
  s_barrier
  v_lshlrev_b32 v228, 4, v9
  ds_read_b128 v[200:203], v228 offset:2560
  ds_read_b128 v[204:207], v228 offset:2624
  ds_read_b128 v[208:211], v228 offset:2688
  ds_read_b128 v[212:215], v228 offset:2752
  ds_read_b32 v229, v228 offset:2944
  s_branch L_main
L_P:
  s_load_dwordx8 s[60:67], s[0:1], 64
  s_load_dwordx2 s[68:69], s[0:1], 96
  v_and_b32 v0, 63, v0
  v_lshrrev_b32 v9, 4, v0
  v_lshlrev_b32 v3, 4, v0
  s_lshr_b32 s72, s71, 3
  s_and_b32 s73, s71, 7
  v_lshlrev_b32 v39, 2, v0
  s_waitcnt lgkmcnt(0)
  s_load_dword s3, s[68:69], 0
  global_load_dwordx4 v[16:19], v3, s[44:45]
  global_load_dword v20, v39, s[44:45] offset:1024
  s_mul_i32 s75, s73, 80
  s_lshl_b32 s79, s75, 13
  s_lshl_b32 s76, s70, 6
  s_add_u32 s79, s79, s76
  s_lshl_b32 s77, s72, 8
  s_add_u32 s12, s50, s77
  s_addc_u32 s13, s51, 0
  s_and_b32 s13, s13, 0xffff
  s_mov_b32 s14, 5234944
  s_mov_b32 s15, 0x20000
  v_lshrrev_b32 v32, 2, v0
  v_and_b32 v33, 3, v0
  v_lshlrev_b32 v40, 13, v32
  v_lshl_add_u32 v40, v33, 4, v40
  buffer_load_dwordx4 v[48:51], v40, s[12:15], s79 offen
  s_add_u32 s79, s79, 131072
  buffer_load_dwordx4 v[52:55], v40, s[12:15], s79 offen
  s_add_u32 s79, s79, 131072
  buffer_load_dwordx4 v[56:59], v40, s[12:15], s79 offen
  s_add_u32 s79, s79, 131072
  buffer_load_dwordx4 v[60:63], v40, s[12:15], s79 offen
  s_add_u32 s79, s79, 131072
  buffer_load_dwordx4 v[64:67], v40, s[12:15], s79 offen
  s_lshl_b32 s76, 1, s72
  s_sub_u32 s78, s76, 1
  s_and_b32 s78, s78, 0xfdfdf9fd
  s_bcnt1_i32_b32 s55, s78
  s_and_b32 s76, s76, 0xfdfdf9fd
  s_cselect_b32 s55, s55, 27
  s_mul_i32 s79, s75, 3456
  s_lshl_b32 s76, s70, 5
  s_add_u32 s79, s79, s76
  s_lshl_b32 s78, s55, 7
  s_cmp_lt_u32 s55, 27
  s_cselect_b32 s76, 2208512, 0
  s_add_u32 s20, s56, s78
  s_addc_u32 s21, s57, 0
  s_and_b32 s21, s21, 0xffff
  s_mov_b32 s22, s76
  s_mov_b32 s23, 0x20000
  v_mul_u32_u24 v41, 3456, v32
  v_lshl_add_u32 v41, v33, 3, v41
  buffer_load_dwordx2 v[68:69], v41, s[20:23], s79 offen
  s_add_u32 s79, s79, 55296
  buffer_load_dwordx2 v[70:71], v41, s[20:23], s79 offen
  s_add_u32 s79, s79, 55296
  buffer_load_dwordx2 v[72:73], v41, s[20:23], s79 offen
  s_add_u32 s79, s79, 55296
  buffer_load_dwordx2 v[74:75], v41, s[20:23], s79 offen
  s_add_u32 s79, s79, 55296
  buffer_load_dwordx2 v[76:77], v41, s[20:23], s79 offen
  s_cmp_lt_u32 s55, 27
  s_cselect_b32 s76, 128, 0
  s_cselect_b32 s78, s78, 0
  s_add_u32 s32, s58, s78
  s_addc_u32 s33, s59, 0
  s_and_b32 s33, s33, 0xffff
  s_mov_b32 s34, s76
  s_mov_b32 s35, 0x20000
  s_lshl_b32 s76, s70, 5
  v_lshlrev_b32 v244, 1, v8
  buffer_load_ushort v244, v244, s[32:35], s76 offen
  v_lshlrev_b32 v2, 6, v229
  v_lshl_or_b32 v2, v8, 4, v2
  s_lshl_b32 s77, s71, 19
  s_lshl_b32 s78, s70, 12
  s_add_u32 s77, s77, s78
  s_add_u32 s4, s46, s77
  s_addc_u32 s5, s47, 0
  s_and_b32 s5, s5, 0xffff
  s_mov_b32 s6, 495616
  s_mov_b32 s7, 0x20000
  s_add_u32 s8, s48, s77
  s_addc_u32 s9, s49, 0
  s_and_b32 s9, s9, 0xffff
  s_mov_b32 s10, 495616
  s_mov_b32 s11, 0x20000
  s_mov_b32 s74, 0
  s_getreg_b32 s80, hwreg(HW_REG_XCC_ID, 0, 3)
  v_lshlrev_b32 v246, 6, v33
  v_lshl_add_u32 v246, v9, 4, v246
  v_lshlrev_b32 v245, 10, v9
  v_lshl_add_u32 v245, v8, 4, v245
  s_lshl_b32 s76, s70, 6
  s_add_u32 s76, s76, 2560
  v_lshl_add_u32 v247, v8, 2, s76
  v_lshl_add_u32 v247, v9, 1, v247
  s_lshl_b32 s76, s70, 5
  s_add_u32 s76, s76, 2816
  v_lshl_add_u32 v248, v8, 1, s76
  v_lshlrev_b32 v32, 1, v32
  s_lshl_b32 s75, s75, 1
  v_add_u32 v40, s75, v32
  s_and_b32 s81, s73, 3
  s_lshr_b32 s82, s73, 2
  s_mov_b32 s28, s68
  s_and_b32 s29, s69, 0xffff
  s_mov_b32 s30, 8388608
  s_mov_b32 s31, 0x20000
  s_mov_b32 s96, 0x05040100
  s_mov_b32 s97, 0x07060302
  s_mov_b32 s98, 0x3fb8aa3b
  s_mov_b32 s99, 0x3db504f3
  s_mov_b32 s86, 0
  s_mov_b32 s87, -1
  s_mov_b32 s84, 0xffff0000
  s_mov_b32 s85, 0xffff0000
  s_mul_i32 s94, s72, 34816
  s_lshl_b32 s75, s73, 8
  s_lshl_b32 s76, s70, 6
  s_add_u32 s94, s94, s75
  s_add_u32 s94, s94, s76
  s_add_u32 s94, s94, 262912
  v_mul_u32_u24 v5, 2176, v8
  v_lshl_add_u32 v5, v9, 4, v5
  v_mov_b32 v216, 0
  v_mov_b32 v217, 0
  v_mov_b32 v218, 0
  v_mov_b32 v219, 0
  v_mov_b32 v220, 0
  v_mov_b32 v221, 0
  v_mov_b32 v222, 0
  v_mov_b32 v223, 0
  v_mov_b32 v4, 0
  v_mov_b32 v6, 0xff7fffff
  v_cndmask_b32_e64 v247, v247, v248, s[86:87]
  v_mov_b32 v37, v3
  v_add_u32 v38, 1024, v39
  s_mov_b32 s78, 2
  s_waitcnt vmcnt(11) lgkmcnt(0)
  s_add_u32 s3, s3, 0x9e3779b9
L_ln:
  v_lshlrev_b32 v22, 16, v16
  v_and_b32 v23, 0xffff0000, v16
  v_lshlrev_b32 v24, 16, v17
  v_and_b32 v25, 0xffff0000, v17
  v_lshlrev_b32 v26, 16, v18
  v_and_b32 v27, 0xffff0000, v18
  v_lshlrev_b32 v28, 16, v19
  v_and_b32 v29, 0xffff0000, v19
  v_lshlrev_b32 v30, 16, v20
  v_and_b32 v31, 0xffff0000, v20
  v_add_f32 v32, v22, v23
  v_add_f32 v33, v24, v25
  v_add_f32 v32, v32, v26
  v_add_f32 v33, v33, v27
  v_add_f32 v32, v32, v28
  v_add_f32 v33, v33, v29
  v_add_f32 v32, v32, v30
  v_add_f32 v33, v33, v31
  v_add_f32 v32, v32, v33
  s_nop 1
  v_add_f32_dpp v32, v32, v32 row_ror:8 row_mask:0xf bank_mask:0xf
  s_nop 1
  v_add_f32_dpp v32, v32, v32 row_ror:4 row_mask:0xf bank_mask:0xf
  s_nop 1
  v_add_f32_dpp v32, v32, v32 row_ror:2 row_mask:0xf bank_mask:0xf
  s_nop 1
  v_add_f32_dpp v32, v32, v32 row_ror:1 row_mask:0xf bank_mask:0xf
  v_mov_b32 v33, v32
  s_nop 1
  v_permlane32_swap_b32 v32, v33
  v_add_f32 v32, v32, v33
  v_mov_b32 v33, v32
  s_nop 1
  v_permlane16_swap_b32 v32, v33
  v_add_f32 v32, v32, v33
  v_mul_f32 v32, 0x3acccccd, v32
  v_sub_f32 v34, v22, v32
  v_mul_f32 v33, v34, v34
  v_sub_f32 v35, v23, v32
  v_fmac_f32 v33, v35, v35
  v_sub_f32 v34, v24, v32
  v_fmac_f32 v33, v34, v34
  v_sub_f32 v35, v25, v32
  v_fmac_f32 v33, v35, v35
  v_sub_f32 v34, v26, v32
  v_fmac_f32 v33, v34, v34
  v_sub_f32 v35, v27, v32
  v_fmac_f32 v33, v35, v35
  v_sub_f32 v34, v28, v32
  v_fmac_f32 v33, v34, v34
  v_sub_f32 v35, v29, v32
  v_fmac_f32 v33, v35, v35
  v_sub_f32 v34, v30, v32
  v_fmac_f32 v33, v34, v34
  v_sub_f32 v35, v31, v32
  v_fmac_f32 v33, v35, v35
  s_nop 1
  v_add_f32_dpp v33, v33, v33 row_ror:8 row_mask:0xf bank_mask:0xf
  s_nop 1
  v_add_f32_dpp v33, v33, v33 row_ror:4 row_mask:0xf bank_mask:0xf
  s_nop 1
  v_add_f32_dpp v33, v33, v33 row_ror:2 row_mask:0xf bank_mask:0xf
  s_nop 1
  v_add_f32_dpp v33, v33, v33 row_ror:1 row_mask:0xf bank_mask:0xf
  v_mov_b32 v34, v33
  s_nop 1
  v_permlane32_swap_b32 v33, v34
  v_add_f32 v33, v33, v34
  v_mov_b32 v34, v33
  s_nop 1
  v_permlane16_swap_b32 v33, v34
  v_add_f32 v33, v33, v34
  v_mul_f32 v33, 0x3acccccd, v33
  v_cvt_pk_bf16_f32 v33, v33, v33
  v_lshlrev_b32 v33, 16, v33
  v_add_f32 v33, 0x3727c5ac, v33
  v_cvt_pk_bf16_f32 v33, v33, v33
  v_lshlrev_b32 v33, 16, v33
  v_sqrt_f32 v33, v33
  v_cvt_pk_bf16_f32 v32, v32, v32
  v_lshlrev_b32 v32, 16, v32
  v_cvt_pk_bf16_f32 v33, v33, v33
  v_lshlrev_b32 v33, 16, v33
  v_rcp_f32 v34, v33
  v_sub_f32 v22, v22, v32
  v_sub_f32 v23, v23, v32
  v_sub_f32 v24, v24, v32
  v_sub_f32 v25, v25, v32
  v_sub_f32 v26, v26, v32
  v_sub_f32 v27, v27, v32
  v_sub_f32 v28, v28, v32
  v_sub_f32 v29, v29, v32
  v_sub_f32 v30, v30, v32
  v_sub_f32 v31, v31, v32
  v_cvt_pk_bf16_f32 v16, v22, v23
  v_cvt_pk_bf16_f32 v17, v24, v25
  v_cvt_pk_bf16_f32 v18, v26, v27
  v_cvt_pk_bf16_f32 v19, v28, v29
  v_cvt_pk_bf16_f32 v20, v30, v31
  v_lshlrev_b32 v22, 16, v16
  v_and_b32 v23, 0xffff0000, v16
  v_lshlrev_b32 v24, 16, v17
  v_and_b32 v25, 0xffff0000, v17
  v_lshlrev_b32 v26, 16, v18
  v_and_b32 v27, 0xffff0000, v18
  v_lshlrev_b32 v28, 16, v19
  v_and_b32 v29, 0xffff0000, v19
  v_lshlrev_b32 v30, 16, v20
  v_and_b32 v31, 0xffff0000, v20
  v_mul_f32 v35, v22, v34
  v_mul_f32 v36, v23, v34
  v_fma_f32 v22, -v35, v33, v22
  v_fma_f32 v23, -v36, v33, v23
  v_fmac_f32 v35, v22, v34
  v_fmac_f32 v36, v23, v34
  v_cvt_pk_bf16_f32 v16, v35, v36
  v_mul_f32 v35, v24, v34
  v_mul_f32 v36, v25, v34
  v_fma_f32 v24, -v35, v33, v24
  v_fma_f32 v25, -v36, v33, v25
  v_fmac_f32 v35, v24, v34
  v_fmac_f32 v36, v25, v34
  v_cvt_pk_bf16_f32 v17, v35, v36
  v_mul_f32 v35, v26, v34
  v_mul_f32 v36, v27, v34
  v_fma_f32 v26, -v35, v33, v26
  v_fma_f32 v27, -v36, v33, v27
  v_fmac_f32 v35, v26, v34
  v_fmac_f32 v36, v27, v34
  v_cvt_pk_bf16_f32 v18, v35, v36
  v_mul_f32 v35, v28, v34
  v_mul_f32 v36, v29, v34
  v_fma_f32 v28, -v35, v33, v28
  v_fma_f32 v29, -v36, v33, v29
  v_fmac_f32 v35, v28, v34
  v_fmac_f32 v36, v29, v34
  v_cvt_pk_bf16_f32 v19, v35, v36
  v_mul_f32 v35, v30, v34
  v_mul_f32 v36, v31, v34
  v_fma_f32 v30, -v35, v33, v30
  v_fma_f32 v31, -v36, v33, v31
  v_fmac_f32 v35, v30, v34
  v_fmac_f32 v36, v31, v34
  v_cvt_pk_bf16_f32 v20, v35, v36
  ds_write_b128 v37, v[16:19]
  ds_write_b32 v38, v20
  v_add_u32 v37, 1280, v37
  v_add_u32 v38, 1280, v38
  s_sub_u32 s78, s78, 1
  s_cmp_lg_u32 s78, 0
  s_cbranch_scc1 L_ln
  s_waitcnt lgkmcnt(0)
  ds_read_u16 v78, v40 offset:0
  ds_read_u16 v79, v40 offset:32
  ds_read_u16 v80, v40 offset:64
  ds_read_u16 v81, v40 offset:96
  ds_read_u16 v82, v40 offset:128
  ds_read_u16 v88, v40 offset:1280
  ds_read_u16 v89, v40 offset:1312
  ds_read_u16 v90, v40 offset:1344
  ds_read_u16 v91, v40 offset:1376
  ds_read_u16 v92, v40 offset:1408
  s_lshl_b32 s80, s80, 29
  s_xor_b32 s76, s3, s80
  v_mov_b32 v235, s76
  s_lshl_b32 s76, s70, 8
  s_lshl_b32 s75, s71, 10
  s_add_u32 s75, s75, s76
  s_lshl_b32 s77, s72, 13
  s_add_u32 s77, s77, s76
  s_add_u32 s78, s77, 4096
  s_waitcnt lgkmcnt(0)
  v_lshlrev_b32 v83, 16, v78
  v_lshlrev_b32 v93, 16, v88
  v_lshlrev_b32 v84, 16, v79
  v_lshlrev_b32 v94, 16, v89
  v_lshlrev_b32 v85, 16, v80
  v_lshlrev_b32 v95, 16, v90
  v_lshlrev_b32 v86, 16, v81
  v_lshlrev_b32 v96, 16, v91
  v_lshlrev_b32 v87, 16, v82
  v_lshlrev_b32 v97, 16, v92
  s_waitcnt vmcnt(1)
  v_dot2_f32_bf16 v98, v48, v78, 0
  v_dot2_f32_bf16 v99, v48, v83, 0
  v_dot2_f32_bf16 v100, v49, v78, 0
  v_dot2_f32_bf16 v101, v49, v83, 0
  v_dot2_f32_bf16 v102, v50, v78, 0
  v_dot2_f32_bf16 v103, v50, v83, 0
  v_dot2_f32_bf16 v104, v51, v78, 0
  v_dot2_f32_bf16 v105, v51, v83, 0
  v_dot2_f32_bf16 v106, v68, v88, 0
  v_dot2_f32_bf16 v107, v68, v93, 0
  v_dot2_f32_bf16 v108, v69, v88, 0
  v_dot2_f32_bf16 v109, v69, v93, 0
  v_dot2c_f32_bf16 v98, v52, v79
  v_dot2c_f32_bf16 v99, v52, v84
  v_dot2c_f32_bf16 v100, v53, v79
  v_dot2c_f32_bf16 v101, v53, v84
  v_dot2c_f32_bf16 v102, v54, v79
  v_dot2c_f32_bf16 v103, v54, v84
  v_dot2c_f32_bf16 v104, v55, v79
  v_dot2c_f32_bf16 v105, v55, v84
  v_dot2c_f32_bf16 v106, v70, v89
  v_dot2c_f32_bf16 v107, v70, v94
  v_dot2c_f32_bf16 v108, v71, v89
  v_dot2c_f32_bf16 v109, v71, v94
  v_dot2c_f32_bf16 v98, v56, v80
  v_dot2c_f32_bf16 v99, v56, v85
  v_dot2c_f32_bf16 v100, v57, v80
  v_dot2c_f32_bf16 v101, v57, v85
  v_dot2c_f32_bf16 v102, v58, v80
  v_dot2c_f32_bf16 v103, v58, v85
  v_dot2c_f32_bf16 v104, v59, v80
  v_dot2c_f32_bf16 v105, v59, v85
  v_dot2c_f32_bf16 v106, v72, v90
  v_dot2c_f32_bf16 v107, v72, v95
  v_dot2c_f32_bf16 v108, v73, v90
  v_dot2c_f32_bf16 v109, v73, v95
  v_dot2c_f32_bf16 v98, v60, v81
  v_dot2c_f32_bf16 v99, v60, v86
  v_dot2c_f32_bf16 v100, v61, v81
  v_dot2c_f32_bf16 v101, v61, v86
  v_dot2c_f32_bf16 v102, v62, v81
  v_dot2c_f32_bf16 v103, v62, v86
  v_dot2c_f32_bf16 v104, v63, v81
  v_dot2c_f32_bf16 v105, v63, v86
  v_dot2c_f32_bf16 v106, v74, v91
  v_dot2c_f32_bf16 v107, v74, v96
  v_dot2c_f32_bf16 v108, v75, v91
  v_dot2c_f32_bf16 v109, v75, v96
  v_dot2c_f32_bf16 v98, v64, v82
  v_dot2c_f32_bf16 v99, v64, v87
  v_dot2c_f32_bf16 v100, v65, v82
  v_dot2c_f32_bf16 v101, v65, v87
  v_dot2c_f32_bf16 v102, v66, v82
  v_dot2c_f32_bf16 v103, v66, v87
  v_dot2c_f32_bf16 v104, v67, v82
  v_dot2c_f32_bf16 v105, v67, v87
  v_dot2c_f32_bf16 v106, v76, v92
  v_dot2c_f32_bf16 v107, v76, v97
  v_dot2c_f32_bf16 v108, v77, v92
  v_dot2c_f32_bf16 v109, v77, v97
  v_permlane32_swap_b32 v98, v102
  v_permlane32_swap_b32 v99, v103
  v_permlane32_swap_b32 v100, v104
  v_permlane32_swap_b32 v101, v105
  v_add_f32 v98, v98, v102
  v_add_f32 v99, v99, v103
  v_add_f32 v100, v100, v104
  v_add_f32 v101, v101, v105
  s_nop 0
  v_permlane16_swap_b32 v98, v100
  v_permlane16_swap_b32 v99, v101
  v_add_f32 v98, v98, v100
  v_add_f32 v99, v99, v101
  v_permlane32_swap_b32 v106, v108
  v_permlane32_swap_b32 v107, v109
  v_add_f32 v106, v106, v108
  v_add_f32 v107, v107, v109
  s_nop 1
  v_permlane16_swap_b32 v106, v107
  v_add_f32 v106, v106, v107
  v_add_f32_dpp v98, v98, v98 row_ror:4 row_mask:0xf bank_mask:0xf
  v_add_f32_dpp v99, v99, v99 row_ror:4 row_mask:0xf bank_mask:0xf
  v_add_f32_dpp v106, v106, v106 row_ror:4 row_mask:0xf bank_mask:0xf
  v_add_f32_dpp v98, v98, v98 row_ror:8 row_mask:0xf bank_mask:0xf
  v_add_f32_dpp v99, v99, v99 row_ror:8 row_mask:0xf bank_mask:0xf
  v_add_f32_dpp v106, v106, v106 row_ror:8 row_mask:0xf bank_mask:0xf
  v_mov_b32 v232, v98
  v_mov_b32 v233, v99
  v_mov_b32 v234, v106
  s_mov_b32 exec_lo, 0x000f000f
  s_mov_b32 exec_hi, 0x000f000f
  buffer_store_dwordx4 v[232:235], v246, s[28:31], s75 offen offset:1024 sc1
  s_mov_b64 exec, -1
  buffer_load_dwordx4 v[16:19], v1, s[4:7], s74 offen offset:0 nt
  buffer_load_dwordx4 v[20:23], v1, s[4:7], s74 offen offset:64 nt
  buffer_load_dwordx4 v[24:27], v1, s[4:7], s74 offen offset:128 nt
  buffer_load_dwordx4 v[28:31], v1, s[4:7], s74 offen offset:192 nt
  buffer_load_dwordx4 v[32:35], v2, s[8:11], s74 offen offset:0 nt
  buffer_load_dwordx4 v[36:39], v2, s[8:11], s74 offen offset:256 nt
  buffer_load_dwordx4 v[40:43], v2, s[8:11], s74 offen offset:512 nt
  buffer_load_dwordx4 v[44:47], v2, s[8:11], s74 offen offset:768 nt
  s_add_u32 s74, s74, 32768
  buffer_load_dwordx4 v[48:51], v1, s[4:7], s74 offen offset:0 nt
  buffer_load_dwordx4 v[52:55], v1, s[4:7], s74 offen offset:64 nt
  buffer_load_dwordx4 v[56:59], v1, s[4:7], s74 offen offset:128 nt
  buffer_load_dwordx4 v[60:63], v1, s[4:7], s74 offen offset:192 nt
  buffer_load_dwordx4 v[64:67], v2, s[8:11], s74 offen offset:0 nt
  buffer_load_dwordx4 v[68:71], v2, s[8:11], s74 offen offset:256 nt
  buffer_load_dwordx4 v[72:75], v2, s[8:11], s74 offen offset:512 nt
  buffer_load_dwordx4 v[76:79], v2, s[8:11], s74 offen offset:768 nt
  s_add_u32 s74, s74, 32768
  buffer_load_dwordx4 v[80:83], v1, s[4:7], s74 offen offset:0 nt
  buffer_load_dwordx4 v[84:87], v1, s[4:7], s74 offen offset:64 nt
  buffer_load_dwordx4 v[88:91], v1, s[4:7], s74 offen offset:128 nt
  buffer_load_dwordx4 v[92:95], v1, s[4:7], s74 offen offset:192 nt
  buffer_load_dwordx4 v[96:99], v2, s[8:11], s74 offen offset:0 nt
  buffer_load_dwordx4 v[100:103], v2, s[8:11], s74 offen offset:256 nt
  buffer_load_dwordx4 v[104:107], v2, s[8:11], s74 offen offset:512 nt
  buffer_load_dwordx4 v[108:111], v2, s[8:11], s74 offen offset:768 nt
  s_mov_b32 s83, 65536
L_gath:
  buffer_load_dwordx4 v[236:239], v245, s[28:31], s77 offen offset:1024 sc1
  buffer_load_dwordx4 v[240:243], v245, s[28:31], s78 offen offset:1024 sc1
  s_waitcnt vmcnt(0)
  v_xor_b32 v239, s3, v239
  v_xor_b32 v243, s3, v243
  v_or_b32 v249, v239, v243
  v_lshlrev_b32 v249, 3, v249
  v_cmp_ne_u32 vcc, 0, v249
  s_nop 0
  s_cbranch_vccz L_qok
  s_sub_u32 s83, s83, 1
  s_cmp_gt_i32 s83, 0
  s_cbranch_scc1 L_gath
L_qok:
  v_cmp_ne_u32 vcc, s80, v239
  v_cmp_ne_u32 s[88:89], s80, v243
  v_pk_add_f32 v[236:237], v[236:237], v[240:241]
  v_add_f32 v238, v238, v242
  s_or_b64 vcc, vcc, s[88:89]
  s_cselect_b32 s95, 0, 1
  v_mov_b32 v240, v237
  v_permlane32_swap_b32 v236, v238
  s_nop 0
  v_permlane32_swap_b32 v237, v240
  v_add_f32 v236, v236, v238
  v_add_f32 v237, v237, v240
  s_nop 1
  v_permlane16_swap_b32 v236, v237
  v_add_f32 v236, v236, v237
  v_mov_b32 v240, s95
  v_mov_b32 v241, 2944
  ds_write_b32 v241, v240
  v_cvt_pk_bf16_f32 v248, v236, v236
  v_lshlrev_b32 v248, 16, v248
  v_lshlrev_b32 v244, 16, v244
  v_add_f32 v248, v248, v244
  v_cvt_pk_bf16_f32 v248, v248, v248
  v_lshlrev_b32 v248, 16, v248
  v_mul_f32 v249, v248, v248
  v_mul_f32 v249, v249, v248
  v_mul_f32 v249, 0x3d372713, v249
  v_add_f32 v249, v249, v248
  v_mul_f32 v249, 0xc0135761, v249
  v_exp_f32 v249, v249
  s_nop 0
  v_add_f32 v249, 1.0, v249
  v_rcp_f32 v249, v249
  s_nop 0
  v_mul_f32 v248, v248, v249
  v_cndmask_b32_e64 v248, v236, v248, s[86:87]
  v_cvt_pk_bf16_f32 v248, v248, v248
  s_mov_b32 exec_hi, 0xffff
  ds_write_b16 v247, v248
  s_mov_b64 exec, -1
  s_waitcnt lgkmcnt(0)
  s_barrier
  v_lshlrev_b32 v228, 4, v9
  ds_read_b128 v[200:203], v228 offset:2560
  ds_read_b128 v[204:207], v228 offset:2624
  ds_read_b128 v[208:211], v228 offset:2688
  ds_read_b128 v[212:215], v228 offset:2752
  ds_read_b32 v229, v228 offset:2944
  s_add_u32 s74, s74, 32768
  buffer_load_dwordx4 v[112:115], v1, s[4:7], s74 offen offset:0 nt
  buffer_load_dwordx4 v[116:119], v1, s[4:7], s74 offen offset:64 nt
  buffer_load_dwordx4 v[120:123], v1, s[4:7], s74 offen offset:128 nt
  buffer_load_dwordx4 v[124:127], v1, s[4:7], s74 offen offset:192 nt
  buffer_load_dwordx4 v[128:131], v2, s[8:11], s74 offen offset:0 nt
  buffer_load_dwordx4 v[132:135], v2, s[8:11], s74 offen offset:256 nt
  buffer_load_dwordx4 v[136:139], v2, s[8:11], s74 offen offset:512 nt
  buffer_load_dwordx4 v[140:143], v2, s[8:11], s74 offen offset:768 nt
  s_add_u32 s74, s74, 32768
  buffer_load_dwordx4 v[144:147], v1, s[4:7], s74 offen offset:0 nt
  buffer_load_dwordx4 v[148:151], v1, s[4:7], s74 offen offset:64 nt
  buffer_load_dwordx4 v[152:155], v1, s[4:7], s74 offen offset:128 nt
  buffer_load_dwordx4 v[156:159], v1, s[4:7], s74 offen offset:192 nt
  buffer_load_dwordx4 v[160:163], v2, s[8:11], s74 offen offset:0 nt
  buffer_load_dwordx4 v[164:167], v2, s[8:11], s74 offen offset:256 nt
  buffer_load_dwordx4 v[168:171], v2, s[8:11], s74 offen offset:512 nt
  buffer_load_dwordx4 v[172:175], v2, s[8:11], s74 offen offset:768 nt
L_main:
  s_waitcnt lgkmcnt(0)
  v_readfirstlane_b32 s95, v229
  s_waitcnt vmcnt(36)
  v_mfma_f32_16x16x32_bf16 v[224:227], v[16:19], v[200:203], 0
  v_mfma_f32_16x16x32_bf16 v[224:227], v[20:23], v[204:207], v[224:227]
  v_mfma_f32_16x16x32_bf16 v[224:227], v[24:27], v[208:211], v[224:227]
  v_mfma_f32_16x16x32_bf16 v[224:227], v[28:31], v[212:215], v[224:227]
  s_cmp_lt_u32 s70, 4
  s_cbranch_scc0 L_nw2
  s_lshl_b32 s75, s55, 2
  s_add_u32 s75, s75, s81
  s_mul_i32 s77, s82, 640
  s_mul_i32 s76, s75, 20480
  s_add_u32 s76, s76, s77
  s_cmp_lt_u32 s55, 27
  s_cselect_b32 s77, 19840, 0
  s_cselect_b32 s76, s76, 0
  s_add_u32 s24, s60, s76
  s_addc_u32 s25, s61, 0
  s_and_b32 s25, s25, 0xffff
  s_mov_b32 s26, s77
  s_mov_b32 s27, 0x20000
  s_mul_i32 s76, s70, 5120
  s_mov_b32 exec_hi, 0xff
  buffer_load_dwordx4 v[176:179], v3, s[24:27], s76 offen offset:0 nt
  buffer_load_dwordx4 v[180:183], v3, s[24:27], s76 offen offset:1280 nt
  buffer_load_dwordx4 v[184:187], v3, s[24:27], s76 offen offset:2560 nt
  buffer_load_dwordx4 v[188:191], v3, s[24:27], s76 offen offset:3840 nt
  s_mov_b64 exec, -1
L_nw2:
  v_cvt_pk_bf16_f32 v232, v224, v225
  v_cvt_pk_bf16_f32 v233, v226, v227
  v_lshlrev_b32 v228, 16, v232
  v_and_b32 v229, 0xffff0000, v232
  v_lshlrev_b32 v230, 16, v233
  v_and_b32 v231, 0xffff0000, v233
  v_mul_f32 v228, s99, v228
  v_mul_f32 v229, s99, v229
  v_mul_f32 v230, s99, v230
  v_mul_f32 v231, s99, v231
  v_cvt_pk_bf16_f32 v232, v228, v229
  v_cvt_pk_bf16_f32 v233, v230, v231
  v_lshlrev_b32 v228, 16, v232
  v_and_b32 v229, 0xffff0000, v232
  v_lshlrev_b32 v230, 16, v233
  v_and_b32 v231, 0xffff0000, v233
  v_max3_f32 v7, v228, v229, v6
  v_max3_f32 v7, v230, v231, v7
  v_mov_b32 v234, v7
  s_nop 1
  v_permlane32_swap_b32 v7, v234
  v_max_f32 v7, v7, v234
  v_mov_b32 v234, v7
  s_nop 1
  v_permlane16_swap_b32 v7, v234
  v_max_f32 v7, v7, v234
  v_mul_f32 v235, s98, v7
  v_fma_f32 v236, v6, s98, -v235
  v_fma_f32 v237, v228, s98, -v235
  v_fma_f32 v238, v229, s98, -v235
  v_fma_f32 v239, v230, s98, -v235
  v_fma_f32 v240, v231, s98, -v235
  v_exp_f32 v236, v236
  v_exp_f32 v237, v237
  v_exp_f32 v238, v238
  v_exp_f32 v239, v239
  v_exp_f32 v240, v240
  v_mul_f32 v216, v236, v216
  v_mul_f32 v217, v236, v217
  v_mul_f32 v218, v236, v218
  v_mul_f32 v219, v236, v219
  v_mul_f32 v220, v236, v220
  v_mul_f32 v221, v236, v221
  v_mul_f32 v222, v236, v222
  v_mul_f32 v223, v236, v223
  v_add_f32 v249, v237, v238
  v_add_f32 v234, v239, v240
  v_cvt_pk_bf16_f32 v241, v237, 0
  v_cvt_pk_bf16_f32 v245, 0, v237
  v_cvt_pk_bf16_f32 v242, v238, 0
  v_cvt_pk_bf16_f32 v246, 0, v238
  v_cvt_pk_bf16_f32 v243, v239, 0
  v_cvt_pk_bf16_f32 v247, 0, v239
  v_cvt_pk_bf16_f32 v244, v240, 0
  v_cvt_pk_bf16_f32 v248, 0, v240
  v_add_f32 v249, v249, v234
  v_fma_f32 v4, v4, v236, v249
  s_waitcnt vmcnt(32)
  v_dot2c_f32_bf16 v216, v32, v241
  v_dot2c_f32_bf16 v217, v32, v245
  v_dot2c_f32_bf16 v218, v33, v241
  v_dot2c_f32_bf16 v219, v33, v245
  v_dot2c_f32_bf16 v220, v34, v241
  v_dot2c_f32_bf16 v221, v34, v245
  v_dot2c_f32_bf16 v222, v35, v241
  v_dot2c_f32_bf16 v223, v35, v245
  v_dot2c_f32_bf16 v216, v36, v242
  v_dot2c_f32_bf16 v217, v36, v246
  v_dot2c_f32_bf16 v218, v37, v242
  v_dot2c_f32_bf16 v219, v37, v246
  v_dot2c_f32_bf16 v220, v38, v242
  v_dot2c_f32_bf16 v221, v38, v246
  v_dot2c_f32_bf16 v222, v39, v242
  v_dot2c_f32_bf16 v223, v39, v246
  v_dot2c_f32_bf16 v216, v40, v243
  v_dot2c_f32_bf16 v217, v40, v247
  v_dot2c_f32_bf16 v218, v41, v243
  v_dot2c_f32_bf16 v219, v41, v247
  v_dot2c_f32_bf16 v220, v42, v243
  v_dot2c_f32_bf16 v221, v42, v247
  v_dot2c_f32_bf16 v222, v43, v243
  v_dot2c_f32_bf16 v223, v43, v247
  v_dot2c_f32_bf16 v216, v44, v244
  v_dot2c_f32_bf16 v217, v44, v248
  v_dot2c_f32_bf16 v218, v45, v244
  v_dot2c_f32_bf16 v219, v45, v248
  v_dot2c_f32_bf16 v220, v46, v244
  v_dot2c_f32_bf16 v221, v46, v248
  v_dot2c_f32_bf16 v222, v47, v244
  v_dot2c_f32_bf16 v223, v47, v248
  s_waitcnt vmcnt(28)
  v_mfma_f32_16x16x32_bf16 v[224:227], v[48:51], v[200:203], 0
  v_mfma_f32_16x16x32_bf16 v[224:227], v[52:55], v[204:207], v[224:227]
  v_mfma_f32_16x16x32_bf16 v[224:227], v[56:59], v[208:211], v[224:227]
  v_mfma_f32_16x16x32_bf16 v[224:227], v[60:63], v[212:215], v[224:227]
  s_nop 7
  v_cvt_pk_bf16_f32 v232, v224, v225
  v_cvt_pk_bf16_f32 v233, v226, v227
  v_lshlrev_b32 v228, 16, v232
  v_and_b32 v229, 0xffff0000, v232
  v_lshlrev_b32 v230, 16, v233
  v_and_b32 v231, 0xffff0000, v233
  v_mul_f32 v228, s99, v228
  v_mul_f32 v229, s99, v229
  v_mul_f32 v230, s99, v230
  v_mul_f32 v231, s99, v231
  v_cvt_pk_bf16_f32 v232, v228, v229
  v_cvt_pk_bf16_f32 v233, v230, v231
  v_lshlrev_b32 v228, 16, v232
  v_and_b32 v229, 0xffff0000, v232
  v_lshlrev_b32 v230, 16, v233
  v_and_b32 v231, 0xffff0000, v233
  v_max3_f32 v6, v228, v229, v7
  v_max3_f32 v6, v230, v231, v6
  v_mov_b32 v234, v6
  s_nop 1
  v_permlane32_swap_b32 v6, v234
  v_max_f32 v6, v6, v234
  v_mov_b32 v234, v6
  s_nop 1
  v_permlane16_swap_b32 v6, v234
  v_max_f32 v6, v6, v234
  v_mul_f32 v235, s98, v6
  v_fma_f32 v236, v7, s98, -v235
  v_fma_f32 v237, v228, s98, -v235
  v_fma_f32 v238, v229, s98, -v235
  v_fma_f32 v239, v230, s98, -v235
  v_fma_f32 v240, v231, s98, -v235
  v_exp_f32 v236, v236
  v_exp_f32 v237, v237
  v_exp_f32 v238, v238
  v_exp_f32 v239, v239
  v_exp_f32 v240, v240
  v_mul_f32 v216, v236, v216
  v_mul_f32 v217, v236, v217
  v_mul_f32 v218, v236, v218
  v_mul_f32 v219, v236, v219
  v_mul_f32 v220, v236, v220
  v_mul_f32 v221, v236, v221
  v_mul_f32 v222, v236, v222
  v_mul_f32 v223, v236, v223
  v_add_f32 v249, v237, v238
  v_add_f32 v234, v239, v240
  v_cvt_pk_bf16_f32 v241, v237, 0
  v_cvt_pk_bf16_f32 v245, 0, v237
  v_cvt_pk_bf16_f32 v242, v238, 0
  v_cvt_pk_bf16_f32 v246, 0, v238
  v_cvt_pk_bf16_f32 v243, v239, 0
  v_cvt_pk_bf16_f32 v247, 0, v239
  v_cvt_pk_bf16_f32 v244, v240, 0
  v_cvt_pk_bf16_f32 v248, 0, v240
  v_add_f32 v249, v249, v234
  v_fma_f32 v4, v4, v236, v249
  s_waitcnt vmcnt(24)
  v_dot2c_f32_bf16 v216, v64, v241
  v_dot2c_f32_bf16 v217, v64, v245
  v_dot2c_f32_bf16 v218, v65, v241
  v_dot2c_f32_bf16 v219, v65, v245
  v_dot2c_f32_bf16 v220, v66, v241
  v_dot2c_f32_bf16 v221, v66, v245
  v_dot2c_f32_bf16 v222, v67, v241
  v_dot2c_f32_bf16 v223, v67, v245
  v_dot2c_f32_bf16 v216, v68, v242
  v_dot2c_f32_bf16 v217, v68, v246
  v_dot2c_f32_bf16 v218, v69, v242
  v_dot2c_f32_bf16 v219, v69, v246
  v_dot2c_f32_bf16 v220, v70, v242
  v_dot2c_f32_bf16 v221, v70, v246
  v_dot2c_f32_bf16 v222, v71, v242
  v_dot2c_f32_bf16 v223, v71, v246
  v_dot2c_f32_bf16 v216, v72, v243
  v_dot2c_f32_bf16 v217, v72, v247
  v_dot2c_f32_bf16 v218, v73, v243
  v_dot2c_f32_bf16 v219, v73, v247
  v_dot2c_f32_bf16 v220, v74, v243
  v_dot2c_f32_bf16 v221, v74, v247
  v_dot2c_f32_bf16 v222, v75, v243
  v_dot2c_f32_bf16 v223, v75, v247
  v_dot2c_f32_bf16 v216, v76, v244
  v_dot2c_f32_bf16 v217, v76, v248
  v_dot2c_f32_bf16 v218, v77, v244
  v_dot2c_f32_bf16 v219, v77, v248
  v_dot2c_f32_bf16 v220, v78, v244
  v_dot2c_f32_bf16 v221, v78, v248
  v_dot2c_f32_bf16 v222, v79, v244
  v_dot2c_f32_bf16 v223, v79, v248
  s_waitcnt vmcnt(20)
  v_mfma_f32_16x16x32_bf16 v[224:227], v[80:83], v[200:203], 0
  v_mfma_f32_16x16x32_bf16 v[224:227], v[84:87], v[204:207], v[224:227]
  v_mfma_f32_16x16x32_bf16 v[224:227], v[88:91], v[208:211], v[224:227]
  v_mfma_f32_16x16x32_bf16 v[224:227], v[92:95], v[212:215], v[224:227]
  s_nop 7
  v_cvt_pk_bf16_f32 v232, v224, v225
  v_cvt_pk_bf16_f32 v233, v226, v227
  v_lshlrev_b32 v228, 16, v232
  v_and_b32 v229, 0xffff0000, v232
  v_lshlrev_b32 v230, 16, v233
  v_and_b32 v231, 0xffff0000, v233
  v_mul_f32 v228, s99, v228
  v_mul_f32 v229, s99, v229
  v_mul_f32 v230, s99, v230
  v_mul_f32 v231, s99, v231
  v_cvt_pk_bf16_f32 v232, v228, v229
  v_cvt_pk_bf16_f32 v233, v230, v231
  v_lshlrev_b32 v228, 16, v232
  v_and_b32 v229, 0xffff0000, v232
  v_lshlrev_b32 v230, 16, v233
  v_and_b32 v231, 0xffff0000, v233
  v_max3_f32 v7, v228, v229, v6
  v_max3_f32 v7, v230, v231, v7
  v_mov_b32 v234, v7
  s_nop 1
  v_permlane32_swap_b32 v7, v234
  v_max_f32 v7, v7, v234
  v_mov_b32 v234, v7
  s_nop 1
  v_permlane16_swap_b32 v7, v234
  v_max_f32 v7, v7, v234
  v_mul_f32 v235, s98, v7
  v_fma_f32 v236, v6, s98, -v235
  v_fma_f32 v237, v228, s98, -v235
  v_fma_f32 v238, v229, s98, -v235
  v_fma_f32 v239, v230, s98, -v235
  v_fma_f32 v240, v231, s98, -v235
  v_exp_f32 v236, v236
  v_exp_f32 v237, v237
  v_exp_f32 v238, v238
  v_exp_f32 v239, v239
  v_exp_f32 v240, v240
  v_mul_f32 v216, v236, v216
  v_mul_f32 v217, v236, v217
  v_mul_f32 v218, v236, v218
  v_mul_f32 v219, v236, v219
  v_mul_f32 v220, v236, v220
  v_mul_f32 v221, v236, v221
  v_mul_f32 v222, v236, v222
  v_mul_f32 v223, v236, v223
  v_add_f32 v249, v237, v238
  v_add_f32 v234, v239, v240
  v_cvt_pk_bf16_f32 v241, v237, 0
  v_cvt_pk_bf16_f32 v245, 0, v237
  v_cvt_pk_bf16_f32 v242, v238, 0
  v_cvt_pk_bf16_f32 v246, 0, v238
  v_cvt_pk_bf16_f32 v243, v239, 0
  v_cvt_pk_bf16_f32 v247, 0, v239
  v_cvt_pk_bf16_f32 v244, v240, 0
  v_cvt_pk_bf16_f32 v248, 0, v240
  v_add_f32 v249, v249, v234
  v_fma_f32 v4, v4, v236, v249
  s_waitcnt vmcnt(16)
  v_dot2c_f32_bf16 v216, v96, v241
  v_dot2c_f32_bf16 v217, v96, v245
  v_dot2c_f32_bf16 v218, v97, v241
  v_dot2c_f32_bf16 v219, v97, v245
  v_dot2c_f32_bf16 v220, v98, v241
  v_dot2c_f32_bf16 v221, v98, v245
  v_dot2c_f32_bf16 v222, v99, v241
  v_dot2c_f32_bf16 v223, v99, v245
  v_dot2c_f32_bf16 v216, v100, v242
  v_dot2c_f32_bf16 v217, v100, v246
  v_dot2c_f32_bf16 v218, v101, v242
  v_dot2c_f32_bf16 v219, v101, v246
  v_dot2c_f32_bf16 v220, v102, v242
  v_dot2c_f32_bf16 v221, v102, v246
  v_dot2c_f32_bf16 v222, v103, v242
  v_dot2c_f32_bf16 v223, v103, v246
  v_dot2c_f32_bf16 v216, v104, v243
  v_dot2c_f32_bf16 v217, v104, v247
  v_dot2c_f32_bf16 v218, v105, v243
  v_dot2c_f32_bf16 v219, v105, v247
  v_dot2c_f32_bf16 v220, v106, v243
  v_dot2c_f32_bf16 v221, v106, v247
  v_dot2c_f32_bf16 v222, v107, v243
  v_dot2c_f32_bf16 v223, v107, v247
  v_dot2c_f32_bf16 v216, v108, v244
  v_dot2c_f32_bf16 v217, v108, v248
  v_dot2c_f32_bf16 v218, v109, v244
  v_dot2c_f32_bf16 v219, v109, v248
  v_dot2c_f32_bf16 v220, v110, v244
  v_dot2c_f32_bf16 v221, v110, v248
  v_dot2c_f32_bf16 v222, v111, v244
  v_dot2c_f32_bf16 v223, v111, v248
  s_waitcnt vmcnt(12)
  v_mfma_f32_16x16x32_bf16 v[224:227], v[112:115], v[200:203], 0
  v_mfma_f32_16x16x32_bf16 v[224:227], v[116:119], v[204:207], v[224:227]
  v_mfma_f32_16x16x32_bf16 v[224:227], v[120:123], v[208:211], v[224:227]
  v_mfma_f32_16x16x32_bf16 v[224:227], v[124:127], v[212:215], v[224:227]
  s_add_u32 s74, s74, 32768
  buffer_load_dwordx4 v[16:19], v1, s[4:7], s74 offen offset:0 nt
  buffer_load_dwordx4 v[20:23], v1, s[4:7], s74 offen offset:64 nt
  buffer_load_dwordx4 v[24:27], v1, s[4:7], s74 offen offset:128 nt
  buffer_load_dwordx4 v[28:31], v1, s[4:7], s74 offen offset:192 nt
  s_nop 2
  v_cvt_pk_bf16_f32 v232, v224, v225
  v_cvt_pk_bf16_f32 v233, v226, v227
  v_lshlrev_b32 v228, 16, v232
  v_and_b32 v229, 0xffff0000, v232
  v_lshlrev_b32 v230, 16, v233
  v_and_b32 v231, 0xffff0000, v233
  v_mul_f32 v228, s99, v228
  v_mul_f32 v229, s99, v229
  v_mul_f32 v230, s99, v230
  v_mul_f32 v231, s99, v231
  v_cvt_pk_bf16_f32 v232, v228, v229
  v_cvt_pk_bf16_f32 v233, v230, v231
  v_lshlrev_b32 v228, 16, v232
  v_and_b32 v229, 0xffff0000, v232
  v_lshlrev_b32 v230, 16, v233
  v_and_b32 v231, 0xffff0000, v233
  v_max3_f32 v6, v228, v229, v7
  v_max3_f32 v6, v230, v231, v6
  v_mov_b32 v234, v6
  s_nop 1
  v_permlane32_swap_b32 v6, v234
  v_max_f32 v6, v6, v234
  v_mov_b32 v234, v6
  s_nop 1
  v_permlane16_swap_b32 v6, v234
  v_max_f32 v6, v6, v234
  v_mul_f32 v235, s98, v6
  v_fma_f32 v236, v7, s98, -v235
  v_fma_f32 v237, v228, s98, -v235
  v_fma_f32 v238, v229, s98, -v235
  v_fma_f32 v239, v230, s98, -v235
  v_fma_f32 v240, v231, s98, -v235
  v_exp_f32 v236, v236
  v_exp_f32 v237, v237
  v_exp_f32 v238, v238
  v_exp_f32 v239, v239
  v_exp_f32 v240, v240
  v_mul_f32 v216, v236, v216
  v_mul_f32 v217, v236, v217
  v_mul_f32 v218, v236, v218
  v_mul_f32 v219, v236, v219
  v_mul_f32 v220, v236, v220
  v_mul_f32 v221, v236, v221
  v_mul_f32 v222, v236, v222
  v_mul_f32 v223, v236, v223
  v_add_f32 v249, v237, v238
  v_add_f32 v234, v239, v240
  v_cvt_pk_bf16_f32 v241, v237, 0
  v_cvt_pk_bf16_f32 v245, 0, v237
  v_cvt_pk_bf16_f32 v242, v238, 0
  v_cvt_pk_bf16_f32 v246, 0, v238
  v_cvt_pk_bf16_f32 v243, v239, 0
  v_cvt_pk_bf16_f32 v247, 0, v239
  v_cvt_pk_bf16_f32 v244, v240, 0
  v_cvt_pk_bf16_f32 v248, 0, v240
  v_add_f32 v249, v249, v234
  v_fma_f32 v4, v4, v236, v249
  s_waitcnt vmcnt(12)
  v_dot2c_f32_bf16 v216, v128, v241
  v_dot2c_f32_bf16 v217, v128, v245
  v_dot2c_f32_bf16 v218, v129, v241
  v_dot2c_f32_bf16 v219, v129, v245
  v_dot2c_f32_bf16 v220, v130, v241
  v_dot2c_f32_bf16 v221, v130, v245
  v_dot2c_f32_bf16 v222, v131, v241
  v_dot2c_f32_bf16 v223, v131, v245
  v_dot2c_f32_bf16 v216, v132, v242
  v_dot2c_f32_bf16 v217, v132, v246
  v_dot2c_f32_bf16 v218, v133, v242
  v_dot2c_f32_bf16 v219, v133, v246
  v_dot2c_f32_bf16 v220, v134, v242
  v_dot2c_f32_bf16 v221, v134, v246
  v_dot2c_f32_bf16 v222, v135, v242
  v_dot2c_f32_bf16 v223, v135, v246
  v_dot2c_f32_bf16 v216, v136, v243
  v_dot2c_f32_bf16 v217, v136, v247
  v_dot2c_f32_bf16 v218, v137, v243
  v_dot2c_f32_bf16 v219, v137, v247
  v_dot2c_f32_bf16 v220, v138, v243
  v_dot2c_f32_bf16 v221, v138, v247
  v_dot2c_f32_bf16 v222, v139, v243
  v_dot2c_f32_bf16 v223, v139, v247
  v_dot2c_f32_bf16 v216, v140, v244
  v_dot2c_f32_bf16 v217, v140, v248
  v_dot2c_f32_bf16 v218, v141, v244
  v_dot2c_f32_bf16 v219, v141, v248
  v_dot2c_f32_bf16 v220, v142, v244
  v_dot2c_f32_bf16 v221, v142, v248
  v_dot2c_f32_bf16 v222, v143, v244
  v_dot2c_f32_bf16 v223, v143, v248
  buffer_load_dwordx4 v[32:35], v2, s[8:11], s74 offen offset:0 nt
  buffer_load_dwordx4 v[36:39], v2, s[8:11], s74 offen offset:256 nt
  buffer_load_dwordx4 v[40:43], v2, s[8:11], s74 offen offset:512 nt
  buffer_load_dwordx4 v[44:47], v2, s[8:11], s74 offen offset:768 nt
  s_cmp_lt_u32 s70, 4
  s_cbranch_scc1 L_nbar3
  s_barrier
  s_mul_i32 s75, s70, 3072
  s_add_u32 s75, s75, 6400
  v_add_u32 v238, s75, v3
  ds_read_b128 v[228:231], v238
  ds_read_b128 v[232:235], v238 offset:1024
  ds_read_b64 v[236:237], v238 offset:2048
  s_waitcnt lgkmcnt(0)
  v_max_f32 v240, v6, v236
  v_mul_f32 v239, s98, v240
  v_fma_f32 v238, v6, s98, -v239
  v_fma_f32 v239, v236, s98, -v239
  v_exp_f32 v238, v238
  v_exp_f32 v239, v239
  v_mov_b32 v6, v240
  v_mul_f32 v237, 0.25, v237
  v_mul_f32 v216, v238, v216
  v_mul_f32 v217, v238, v217
  v_mul_f32 v218, v238, v218
  v_mul_f32 v219, v238, v219
  v_mul_f32 v220, v238, v220
  v_mul_f32 v221, v238, v221
  v_mul_f32 v222, v238, v222
  v_mul_f32 v223, v238, v223
  v_mul_f32 v4, v238, v4
  v_fmac_f32 v216, v239, v228
  v_fmac_f32 v217, v239, v229
  v_fmac_f32 v218, v239, v230
  v_fmac_f32 v219, v239, v231
  v_fmac_f32 v220, v239, v232
  v_fmac_f32 v221, v239, v233
  v_fmac_f32 v222, v239, v234
  v_fmac_f32 v223, v239, v235
  v_fmac_f32 v4, v239, v237
L_nbar3:
  s_waitcnt vmcnt(12)
  v_mfma_f32_16x16x32_bf16 v[224:227], v[144:147], v[200:203], 0
  v_mfma_f32_16x16x32_bf16 v[224:227], v[148:151], v[204:207], v[224:227]
  v_mfma_f32_16x16x32_bf16 v[224:227], v[152:155], v[208:211], v[224:227]
  v_mfma_f32_16x16x32_bf16 v[224:227], v[156:159], v[212:215], v[224:227]
  s_add_u32 s74, s74, 32768
  buffer_load_dwordx4 v[48:51], v1, s[4:7], s74 offen offset:0 nt
  buffer_load_dwordx4 v[52:55], v1, s[4:7], s74 offen offset:64 nt
  buffer_load_dwordx4 v[56:59], v1, s[4:7], s74 offen offset:128 nt
  buffer_load_dwordx4 v[60:63], v1, s[4:7], s74 offen offset:192 nt
  s_nop 2
  v_cvt_pk_bf16_f32 v232, v224, v225
  v_cvt_pk_bf16_f32 v233, v226, v227
  v_lshlrev_b32 v228, 16, v232
  v_and_b32 v229, 0xffff0000, v232
  v_lshlrev_b32 v230, 16, v233
  v_and_b32 v231, 0xffff0000, v233
  v_mul_f32 v228, s99, v228
  v_mul_f32 v229, s99, v229
  v_mul_f32 v230, s99, v230
  v_mul_f32 v231, s99, v231
  v_cvt_pk_bf16_f32 v232, v228, v229
  v_cvt_pk_bf16_f32 v233, v230, v231
  v_lshlrev_b32 v228, 16, v232
  v_and_b32 v229, 0xffff0000, v232
  v_lshlrev_b32 v230, 16, v233
  v_and_b32 v231, 0xffff0000, v233
  v_max3_f32 v7, v228, v229, v6
  v_max3_f32 v7, v230, v231, v7
  v_mov_b32 v234, v7
  s_nop 1
  v_permlane32_swap_b32 v7, v234
  v_max_f32 v7, v7, v234
  v_mov_b32 v234, v7
  s_nop 1
  v_permlane16_swap_b32 v7, v234
  v_max_f32 v7, v7, v234
  v_mul_f32 v235, s98, v7
  v_fma_f32 v236, v6, s98, -v235
  v_fma_f32 v237, v228, s98, -v235
  v_fma_f32 v238, v229, s98, -v235
  v_fma_f32 v239, v230, s98, -v235
  v_fma_f32 v240, v231, s98, -v235
  v_exp_f32 v236, v236
  v_exp_f32 v237, v237
  v_exp_f32 v238, v238
  v_exp_f32 v239, v239
  v_exp_f32 v240, v240
  v_mul_f32 v216, v236, v216
  v_mul_f32 v217, v236, v217
  v_mul_f32 v218, v236, v218
  v_mul_f32 v219, v236, v219
  v_mul_f32 v220, v236, v220
  v_mul_f32 v221, v236, v221
  v_mul_f32 v222, v236, v222
  v_mul_f32 v223, v236, v223
  v_add_f32 v249, v237, v238
  v_add_f32 v234, v239, v240
  v_cvt_pk_bf16_f32 v241, v237, 0
  v_cvt_pk_bf16_f32 v245, 0, v237
  v_cvt_pk_bf16_f32 v242, v238, 0
  v_cvt_pk_bf16_f32 v246, 0, v238
  v_cvt_pk_bf16_f32 v243, v239, 0
  v_cvt_pk_bf16_f32 v247, 0, v239
  v_cvt_pk_bf16_f32 v244, v240, 0
  v_cvt_pk_bf16_f32 v248, 0, v240
  v_add_f32 v249, v249, v234
  v_fma_f32 v4, v4, v236, v249
  s_waitcnt vmcnt(12)
  v_dot2c_f32_bf16 v216, v160, v241
  v_dot2c_f32_bf16 v217, v160, v245
  v_dot2c_f32_bf16 v218, v161, v241
  v_dot2c_f32_bf16 v219, v161, v245
  v_dot2c_f32_bf16 v220, v162, v241
  v_dot2c_f32_bf16 v221, v162, v245
  v_dot2c_f32_bf16 v222, v163, v241
  v_dot2c_f32_bf16 v223, v163, v245
  v_dot2c_f32_bf16 v216, v164, v242
  v_dot2c_f32_bf16 v217, v164, v246
  v_dot2c_f32_bf16 v218, v165, v242
  v_dot2c_f32_bf16 v219, v165, v246
  v_dot2c_f32_bf16 v220, v166, v242
  v_dot2c_f32_bf16 v221, v166, v246
  v_dot2c_f32_bf16 v222, v167, v242
  v_dot2c_f32_bf16 v223, v167, v246
  v_dot2c_f32_bf16 v216, v168, v243
  v_dot2c_f32_bf16 v217, v168, v247
  v_dot2c_f32_bf16 v218, v169, v243
  v_dot2c_f32_bf16 v219, v169, v247
  v_dot2c_f32_bf16 v220, v170, v243
  v_dot2c_f32_bf16 v221, v170, v247
  v_dot2c_f32_bf16 v222, v171, v243
  v_dot2c_f32_bf16 v223, v171, v247
  v_dot2c_f32_bf16 v216, v172, v244
  v_dot2c_f32_bf16 v217, v172, v248
  v_dot2c_f32_bf16 v218, v173, v244
  v_dot2c_f32_bf16 v219, v173, v248
  v_dot2c_f32_bf16 v220, v174, v244
  v_dot2c_f32_bf16 v221, v174, v248
  v_dot2c_f32_bf16 v222, v175, v244
  v_dot2c_f32_bf16 v223, v175, v248
  buffer_load_dwordx4 v[64:67], v2, s[8:11], s74 offen offset:0 nt
  buffer_load_dwordx4 v[68:71], v2, s[8:11], s74 offen offset:256 nt
  buffer_load_dwordx4 v[72:75], v2, s[8:11], s74 offen offset:512 nt
  buffer_load_dwordx4 v[76:79], v2, s[8:11], s74 offen offset:768 nt
  s_waitcnt vmcnt(12)
  v_mfma_f32_16x16x32_bf16 v[224:227], v[16:19], v[200:203], 0
  v_mfma_f32_16x16x32_bf16 v[224:227], v[20:23], v[204:207], v[224:227]
  v_mfma_f32_16x16x32_bf16 v[224:227], v[24:27], v[208:211], v[224:227]
  v_mfma_f32_16x16x32_bf16 v[224:227], v[28:31], v[212:215], v[224:227]
  s_add_u32 s74, s74, 32768
  buffer_load_dwordx4 v[80:83], v1, s[4:7], s74 offen offset:0 nt
  buffer_load_dwordx4 v[84:87], v1, s[4:7], s74 offen offset:64 nt
  buffer_load_dwordx4 v[88:91], v1, s[4:7], s74 offen offset:128 nt
  buffer_load_dwordx4 v[92:95], v1, s[4:7], s74 offen offset:192 nt
  s_nop 2
  v_cvt_pk_bf16_f32 v232, v224, v225
  v_cvt_pk_bf16_f32 v233, v226, v227
  v_lshlrev_b32 v228, 16, v232
  v_and_b32 v229, 0xffff0000, v232
  v_lshlrev_b32 v230, 16, v233
  v_and_b32 v231, 0xffff0000, v233
  v_mul_f32 v228, s99, v228
  v_mul_f32 v229, s99, v229
  v_mul_f32 v230, s99, v230
  v_mul_f32 v231, s99, v231
  v_cvt_pk_bf16_f32 v232, v228, v229
  v_cvt_pk_bf16_f32 v233, v230, v231
  v_lshlrev_b32 v228, 16, v232
  v_and_b32 v229, 0xffff0000, v232
  v_lshlrev_b32 v230, 16, v233
  v_and_b32 v231, 0xffff0000, v233
  v_max3_f32 v6, v228, v229, v7
  v_max3_f32 v6, v230, v231, v6
  v_mov_b32 v234, v6
  s_nop 1
  v_permlane32_swap_b32 v6, v234
  v_max_f32 v6, v6, v234
  v_mov_b32 v234, v6
  s_nop 1
  v_permlane16_swap_b32 v6, v234
  v_max_f32 v6, v6, v234
  v_mul_f32 v235, s98, v6
  v_fma_f32 v236, v7, s98, -v235
  v_fma_f32 v237, v228, s98, -v235
  v_fma_f32 v238, v229, s98, -v235
  v_fma_f32 v239, v230, s98, -v235
  v_fma_f32 v240, v231, s98, -v235
  v_exp_f32 v236, v236
  v_exp_f32 v237, v237
  v_exp_f32 v238, v238
  v_exp_f32 v239, v239
  v_exp_f32 v240, v240
  v_mul_f32 v216, v236, v216
  v_mul_f32 v217, v236, v217
  v_mul_f32 v218, v236, v218
  v_mul_f32 v219, v236, v219
  v_mul_f32 v220, v236, v220
  v_mul_f32 v221, v236, v221
  v_mul_f32 v222, v236, v222
  v_mul_f32 v223, v236, v223
  v_add_f32 v249, v237, v238
  v_add_f32 v234, v239, v240
  v_cvt_pk_bf16_f32 v241, v237, 0
  v_cvt_pk_bf16_f32 v245, 0, v237
  v_cvt_pk_bf16_f32 v242, v238, 0
  v_cvt_pk_bf16_f32 v246, 0, v238
  v_cvt_pk_bf16_f32 v243, v239, 0
  v_cvt_pk_bf16_f32 v247, 0, v239
  v_cvt_pk_bf16_f32 v244, v240, 0
  v_cvt_pk_bf16_f32 v248, 0, v240
  v_add_f32 v249, v249, v234
  v_fma_f32 v4, v4, v236, v249
  s_waitcnt vmcnt(12)
  v_dot2c_f32_bf16 v216, v32, v241
  v_dot2c_f32_bf16 v217, v32, v245
  v_dot2c_f32_bf16 v218, v33, v241
  v_dot2c_f32_bf16 v219, v33, v245
  v_dot2c_f32_bf16 v220, v34, v241
  v_dot2c_f32_bf16 v221, v34, v245
  v_dot2c_f32_bf16 v222, v35, v241
  v_dot2c_f32_bf16 v223, v35, v245
  v_dot2c_f32_bf16 v216, v36, v242
  v_dot2c_f32_bf16 v217, v36, v246
  v_dot2c_f32_bf16 v218, v37, v242
  v_dot2c_f32_bf16 v219, v37, v246
  v_dot2c_f32_bf16 v220, v38, v242
  v_dot2c_f32_bf16 v221, v38, v246
  v_dot2c_f32_bf16 v222, v39, v242
  v_dot2c_f32_bf16 v223, v39, v246
  v_dot2c_f32_bf16 v216, v40, v243
  v_dot2c_f32_bf16 v217, v40, v247
  v_dot2c_f32_bf16 v218, v41, v243
  v_dot2c_f32_bf16 v219, v41, v247
  v_dot2c_f32_bf16 v220, v42, v243
  v_dot2c_f32_bf16 v221, v42, v247
  v_dot2c_f32_bf16 v222, v43, v243
  v_dot2c_f32_bf16 v223, v43, v247
  v_dot2c_f32_bf16 v216, v44, v244
  v_dot2c_f32_bf16 v217, v44, v248
  v_dot2c_f32_bf16 v218, v45, v244
  v_dot2c_f32_bf16 v219, v45, v248
  v_dot2c_f32_bf16 v220, v46, v244
  v_dot2c_f32_bf16 v221, v46, v248
  v_dot2c_f32_bf16 v222, v47, v244
  v_dot2c_f32_bf16 v223, v47, v248
  buffer_load_dwordx4 v[96:99], v2, s[8:11], s74 offen offset:0 nt
  buffer_load_dwordx4 v[100:103], v2, s[8:11], s74 offen offset:256 nt
  buffer_load_dwordx4 v[104:107], v2, s[8:11], s74 offen offset:512 nt
  buffer_load_dwordx4 v[108:111], v2, s[8:11], s74 offen offset:768 nt
  s_cmp_lt_u32 s70, 4
  s_cbranch_scc0 L_nbp
  s_lshl_b32 s75, s81, 2
  s_add_u32 s75, s75, s70
  s_lshl_b32 s75, s75, 3
  v_mov_b32 v244, s75
  ds_read_b64 v[240:241], v244 offset:2816
  s_mul_i32 s75, s70, 1920
  v_mul_u32_u24 v244, 48, v0
  v_add_u32 v244, s75, v244
  s_waitcnt lgkmcnt(0)
  v_perm_b32 v242, v180, v176, s96
  v_perm_b32 v243, v180, v176, s97
  v_dot2_f32_bf16 v228, v242, v240, 0
  v_dot2_f32_bf16 v229, v243, v240, 0
  v_perm_b32 v242, v181, v177, s96
  v_perm_b32 v243, v181, v177, s97
  v_dot2_f32_bf16 v230, v242, v240, 0
  v_dot2_f32_bf16 v232, v243, v240, 0
  v_perm_b32 v242, v182, v178, s96
  v_perm_b32 v243, v182, v178, s97
  v_dot2_f32_bf16 v233, v242, v240, 0
  v_dot2_f32_bf16 v234, v243, v240, 0
  v_perm_b32 v242, v183, v179, s96
  v_perm_b32 v243, v183, v179, s97
  v_dot2_f32_bf16 v236, v242, v240, 0
  v_dot2_f32_bf16 v237, v243, v240, 0
  v_perm_b32 v242, v188, v184, s96
  v_perm_b32 v243, v188, v184, s97
  v_dot2c_f32_bf16 v228, v242, v241
  v_dot2c_f32_bf16 v229, v243, v241
  v_perm_b32 v242, v189, v185, s96
  v_perm_b32 v243, v189, v185, s97
  v_dot2c_f32_bf16 v230, v242, v241
  v_dot2c_f32_bf16 v232, v243, v241
  v_perm_b32 v242, v190, v186, s96
  v_perm_b32 v243, v190, v186, s97
  v_dot2c_f32_bf16 v233, v242, v241
  v_dot2c_f32_bf16 v234, v243, v241
  v_perm_b32 v242, v191, v187, s96
  v_perm_b32 v243, v191, v187, s97
  v_dot2c_f32_bf16 v236, v242, v241
  v_dot2c_f32_bf16 v237, v243, v241
  s_mov_b32 exec_hi, 0xff
  ds_write_b128 v244, v[228:231] offset:10752
  ds_write_b128 v244, v[232:235] offset:10768
  ds_write_b128 v244, v[236:239] offset:10784
  s_mov_b64 exec, -1
L_nbp:
  s_waitcnt vmcnt(12)
  v_mfma_f32_16x16x32_bf16 v[224:227], v[48:51], v[200:203], 0
  v_mfma_f32_16x16x32_bf16 v[224:227], v[52:55], v[204:207], v[224:227]
  v_mfma_f32_16x16x32_bf16 v[224:227], v[56:59], v[208:211], v[224:227]
  v_mfma_f32_16x16x32_bf16 v[224:227], v[60:63], v[212:215], v[224:227]
  s_add_u32 s74, s74, 32768
  buffer_load_dwordx4 v[112:115], v1, s[4:7], s74 offen offset:0 nt
  buffer_load_dwordx4 v[116:119], v1, s[4:7], s74 offen offset:64 nt
  buffer_load_dwordx4 v[120:123], v1, s[4:7], s74 offen offset:128 nt
  buffer_load_dwordx4 v[124:127], v1, s[4:7], s74 offen offset:192 nt
  s_nop 2
  v_cvt_pk_bf16_f32 v232, v224, v225
  v_cvt_pk_bf16_f32 v233, v226, v227
  v_lshlrev_b32 v228, 16, v232
  v_and_b32 v229, 0xffff0000, v232
  v_lshlrev_b32 v230, 16, v233
  v_and_b32 v231, 0xffff0000, v233
  v_mul_f32 v228, s99, v228
  v_mul_f32 v229, s99, v229
  v_mul_f32 v230, s99, v230
  v_mul_f32 v231, s99, v231
  v_cvt_pk_bf16_f32 v232, v228, v229
  v_cvt_pk_bf16_f32 v233, v230, v231
  v_lshlrev_b32 v228, 16, v232
  v_and_b32 v229, 0xffff0000, v232
  v_lshlrev_b32 v230, 16, v233
  v_and_b32 v231, 0xffff0000, v233
  v_max3_f32 v7, v228, v229, v6
  v_max3_f32 v7, v230, v231, v7
  v_mov_b32 v234, v7
  s_nop 1
  v_permlane32_swap_b32 v7, v234
  v_max_f32 v7, v7, v234
  v_mov_b32 v234, v7
  s_nop 1
  v_permlane16_swap_b32 v7, v234
  v_max_f32 v7, v7, v234
  v_mul_f32 v235, s98, v7
  v_fma_f32 v236, v6, s98, -v235
  v_fma_f32 v237, v228, s98, -v235
  v_fma_f32 v238, v229, s98, -v235
  v_fma_f32 v239, v230, s98, -v235
  v_fma_f32 v240, v231, s98, -v235
  v_exp_f32 v236, v236
  v_exp_f32 v237, v237
  v_exp_f32 v238, v238
  v_exp_f32 v239, v239
  v_exp_f32 v240, v240
  v_mul_f32 v216, v236, v216
  v_mul_f32 v217, v236, v217
  v_mul_f32 v218, v236, v218
  v_mul_f32 v219, v236, v219
  v_mul_f32 v220, v236, v220
  v_mul_f32 v221, v236, v221
  v_mul_f32 v222, v236, v222
  v_mul_f32 v223, v236, v223
  v_add_f32 v249, v237, v238
  v_add_f32 v234, v239, v240
  v_cvt_pk_bf16_f32 v241, v237, 0
  v_cvt_pk_bf16_f32 v245, 0, v237
  v_cvt_pk_bf16_f32 v242, v238, 0
  v_cvt_pk_bf16_f32 v246, 0, v238
  v_cvt_pk_bf16_f32 v243, v239, 0
  v_cvt_pk_bf16_f32 v247, 0, v239
  v_cvt_pk_bf16_f32 v244, v240, 0
  v_cvt_pk_bf16_f32 v248, 0, v240
  v_add_f32 v249, v249, v234
  v_fma_f32 v4, v4, v236, v249
  s_waitcnt vmcnt(12)
  v_dot2c_f32_bf16 v216, v64, v241
  v_dot2c_f32_bf16 v217, v64, v245
  v_dot2c_f32_bf16 v218, v65, v241
  v_dot2c_f32_bf16 v219, v65, v245
  v_dot2c_f32_bf16 v220, v66, v241
  v_dot2c_f32_bf16 v221, v66, v245
  v_dot2c_f32_bf16 v222, v67, v241
  v_dot2c_f32_bf16 v223, v67, v245
  v_dot2c_f32_bf16 v216, v68, v242
  v_dot2c_f32_bf16 v217, v68, v246
  v_dot2c_f32_bf16 v218, v69, v242
  v_dot2c_f32_bf16 v219, v69, v246
  v_dot2c_f32_bf16 v220, v70, v242
  v_dot2c_f32_bf16 v221, v70, v246
  v_dot2c_f32_bf16 v222, v71, v242
  v_dot2c_f32_bf16 v223, v71, v246
  v_dot2c_f32_bf16 v216, v72, v243
  v_dot2c_f32_bf16 v217, v72, v247
  v_dot2c_f32_bf16 v218, v73, v243
  v_dot2c_f32_bf16 v219, v73, v247
  v_dot2c_f32_bf16 v220, v74, v243
  v_dot2c_f32_bf16 v221, v74, v247
  v_dot2c_f32_bf16 v222, v75, v243
  v_dot2c_f32_bf16 v223, v75, v247
  v_dot2c_f32_bf16 v216, v76, v244
  v_dot2c_f32_bf16 v217, v76, v248
  v_dot2c_f32_bf16 v218, v77, v244
  v_dot2c_f32_bf16 v219, v77, v248
  v_dot2c_f32_bf16 v220, v78, v244
  v_dot2c_f32_bf16 v221, v78, v248
  v_dot2c_f32_bf16 v222, v79, v244
  v_dot2c_f32_bf16 v223, v79, v248
  buffer_load_dwordx4 v[128:131], v2, s[8:11], s74 offen offset:0 nt
  buffer_load_dwordx4 v[132:135], v2, s[8:11], s74 offen offset:256 nt
  buffer_load_dwordx4 v[136:139], v2, s[8:11], s74 offen offset:512 nt
  buffer_load_dwordx4 v[140:143], v2, s[8:11], s74 offen offset:768 nt
  s_waitcnt vmcnt(12)
  v_mfma_f32_16x16x32_bf16 v[224:227], v[80:83], v[200:203], 0
  v_mfma_f32_16x16x32_bf16 v[224:227], v[84:87], v[204:207], v[224:227]
  v_mfma_f32_16x16x32_bf16 v[224:227], v[88:91], v[208:211], v[224:227]
  v_mfma_f32_16x16x32_bf16 v[224:227], v[92:95], v[212:215], v[224:227]
  s_add_u32 s74, s74, 32768
  buffer_load_dwordx4 v[144:147], v1, s[4:7], s74 offen offset:0 nt
  buffer_load_dwordx4 v[148:151], v1, s[4:7], s74 offen offset:64 nt
  buffer_load_dwordx4 v[152:155], v1, s[4:7], s74 offen offset:128 nt
  buffer_load_dwordx4 v[156:159], v1, s[4:7], s74 offen offset:192 nt
  s_nop 2
  v_cvt_pk_bf16_f32 v232, v224, v225
  v_cvt_pk_bf16_f32 v233, v226, v227
  v_lshlrev_b32 v228, 16, v232
  v_and_b32 v229, 0xffff0000, v232
  v_lshlrev_b32 v230, 16, v233
  v_and_b32 v231, 0xffff0000, v233
  v_mul_f32 v228, s99, v228
  v_mul_f32 v229, s99, v229
  v_mul_f32 v230, s99, v230
  v_mul_f32 v231, s99, v231
  v_cvt_pk_bf16_f32 v232, v228, v229
  v_cvt_pk_bf16_f32 v233, v230, v231
  v_lshlrev_b32 v228, 16, v232
  v_and_b32 v229, 0xffff0000, v232
  v_lshlrev_b32 v230, 16, v233
  v_and_b32 v231, 0xffff0000, v233
  v_max3_f32 v6, v228, v229, v7
  v_max3_f32 v6, v230, v231, v6
  v_mov_b32 v234, v6
  s_nop 1
  v_permlane32_swap_b32 v6, v234
  v_max_f32 v6, v6, v234
  v_mov_b32 v234, v6
  s_nop 1
  v_permlane16_swap_b32 v6, v234
  v_max_f32 v6, v6, v234
  v_mul_f32 v235, s98, v6
  v_fma_f32 v236, v7, s98, -v235
  v_fma_f32 v237, v228, s98, -v235
  v_fma_f32 v238, v229, s98, -v235
  v_fma_f32 v239, v230, s98, -v235
  v_fma_f32 v240, v231, s98, -v235
  v_exp_f32 v236, v236
  v_exp_f32 v237, v237
  v_exp_f32 v238, v238
  v_exp_f32 v239, v239
  v_exp_f32 v240, v240
  v_mul_f32 v216, v236, v216
  v_mul_f32 v217, v236, v217
  v_mul_f32 v218, v236, v218
  v_mul_f32 v219, v236, v219
  v_mul_f32 v220, v236, v220
  v_mul_f32 v221, v236, v221
  v_mul_f32 v222, v236, v222
  v_mul_f32 v223, v236, v223
  v_add_f32 v249, v237, v238
  v_add_f32 v234, v239, v240
  v_cvt_pk_bf16_f32 v241, v237, 0
  v_cvt_pk_bf16_f32 v245, 0, v237
  v_cvt_pk_bf16_f32 v242, v238, 0
  v_cvt_pk_bf16_f32 v246, 0, v238
  v_cvt_pk_bf16_f32 v243, v239, 0
  v_cvt_pk_bf16_f32 v247, 0, v239
  v_cvt_pk_bf16_f32 v244, v240, 0
  v_cvt_pk_bf16_f32 v248, 0, v240
  v_add_f32 v249, v249, v234
  v_fma_f32 v4, v4, v236, v249
  s_waitcnt vmcnt(12)
  v_dot2c_f32_bf16 v216, v96, v241
  v_dot2c_f32_bf16 v217, v96, v245
  v_dot2c_f32_bf16 v218, v97, v241
  v_dot2c_f32_bf16 v219, v97, v245
  v_dot2c_f32_bf16 v220, v98, v241
  v_dot2c_f32_bf16 v221, v98, v245
  v_dot2c_f32_bf16 v222, v99, v241
  v_dot2c_f32_bf16 v223, v99, v245
  v_dot2c_f32_bf16 v216, v100, v242
  v_dot2c_f32_bf16 v217, v100, v246
  v_dot2c_f32_bf16 v218, v101, v242
  v_dot2c_f32_bf16 v219, v101, v246
  v_dot2c_f32_bf16 v220, v102, v242
  v_dot2c_f32_bf16 v221, v102, v246
  v_dot2c_f32_bf16 v222, v103, v242
  v_dot2c_f32_bf16 v223, v103, v246
  v_dot2c_f32_bf16 v216, v104, v243
  v_dot2c_f32_bf16 v217, v104, v247
  v_dot2c_f32_bf16 v218, v105, v243
  v_dot2c_f32_bf16 v219, v105, v247
  v_dot2c_f32_bf16 v220, v106, v243
  v_dot2c_f32_bf16 v221, v106, v247
  v_dot2c_f32_bf16 v222, v107, v243
  v_dot2c_f32_bf16 v223, v107, v247
  v_dot2c_f32_bf16 v216, v108, v244
  v_dot2c_f32_bf16 v217, v108, v248
  v_dot2c_f32_bf16 v218, v109, v244
  v_dot2c_f32_bf16 v219, v109, v248
  v_dot2c_f32_bf16 v220, v110, v244
  v_dot2c_f32_bf16 v221, v110, v248
  v_dot2c_f32_bf16 v222, v111, v244
  v_dot2c_f32_bf16 v223, v111, v248
  buffer_load_dwordx4 v[160:163], v2, s[8:11], s74 offen offset:0 nt
  buffer_load_dwordx4 v[164:167], v2, s[8:11], s74 offen offset:256 nt
  buffer_load_dwordx4 v[168:171], v2, s[8:11], s74 offen offset:512 nt
  buffer_load_dwordx4 v[172:175], v2, s[8:11], s74 offen offset:768 nt
  s_waitcnt vmcnt(12)
  v_mfma_f32_16x16x32_bf16 v[224:227], v[112:115], v[200:203], 0
  v_mfma_f32_16x16x32_bf16 v[224:227], v[116:119], v[204:207], v[224:227]
  v_mfma_f32_16x16x32_bf16 v[224:227], v[120:123], v[208:211], v[224:227]
  v_mfma_f32_16x16x32_bf16 v[224:227], v[124:127], v[212:215], v[224:227]
  s_add_u32 s74, s74, 32768
  buffer_load_dwordx4 v[16:19], v1, s[4:7], s74 offen offset:0 nt
  buffer_load_dwordx4 v[20:23], v1, s[4:7], s74 offen offset:64 nt
  buffer_load_dwordx4 v[24:27], v1, s[4:7], s74 offen offset:128 nt
  buffer_load_dwordx4 v[28:31], v1, s[4:7], s74 offen offset:192 nt
  s_nop 2
  v_cvt_pk_bf16_f32 v232, v224, v225
  v_cvt_pk_bf16_f32 v233, v226, v227
  v_lshlrev_b32 v228, 16, v232
  v_and_b32 v229, 0xffff0000, v232
  v_lshlrev_b32 v230, 16, v233
  v_and_b32 v231, 0xffff0000, v233
  v_mul_f32 v228, s99, v228
  v_mul_f32 v229, s99, v229
  v_mul_f32 v230, s99, v230
  v_mul_f32 v231, s99, v231
  v_cvt_pk_bf16_f32 v232, v228, v229
  v_cvt_pk_bf16_f32 v233, v230, v231
  v_lshlrev_b32 v228, 16, v232
  v_and_b32 v229, 0xffff0000, v232
  v_lshlrev_b32 v230, 16, v233
  v_and_b32 v231, 0xffff0000, v233
  v_max3_f32 v7, v228, v229, v6
  v_max3_f32 v7, v230, v231, v7
  v_mov_b32 v234, v7
  s_nop 1
  v_permlane32_swap_b32 v7, v234
  v_max_f32 v7, v7, v234
  v_mov_b32 v234, v7
  s_nop 1
  v_permlane16_swap_b32 v7, v234
  v_max_f32 v7, v7, v234
  v_mul_f32 v235, s98, v7
  v_fma_f32 v236, v6, s98, -v235
  v_fma_f32 v237, v228, s98, -v235
  v_fma_f32 v238, v229, s98, -v235
  v_fma_f32 v239, v230, s98, -v235
  v_fma_f32 v240, v231, s98, -v235
  v_exp_f32 v236, v236
  v_exp_f32 v237, v237
  v_exp_f32 v238, v238
  v_exp_f32 v239, v239
  v_exp_f32 v240, v240
  v_mul_f32 v216, v236, v216
  v_mul_f32 v217, v236, v217
  v_mul_f32 v218, v236, v218
  v_mul_f32 v219, v236, v219
  v_mul_f32 v220, v236, v220
  v_mul_f32 v221, v236, v221
  v_mul_f32 v222, v236, v222
  v_mul_f32 v223, v236, v223
  v_add_f32 v249, v237, v238
  v_add_f32 v234, v239, v240
  v_cvt_pk_bf16_f32 v241, v237, 0
  v_cvt_pk_bf16_f32 v245, 0, v237
  v_cvt_pk_bf16_f32 v242, v238, 0
  v_cvt_pk_bf16_f32 v246, 0, v238
  v_cvt_pk_bf16_f32 v243, v239, 0
  v_cvt_pk_bf16_f32 v247, 0, v239
  v_cvt_pk_bf16_f32 v244, v240, 0
  v_cvt_pk_bf16_f32 v248, 0, v240
  v_add_f32 v249, v249, v234
  v_fma_f32 v4, v4, v236, v249
  s_waitcnt vmcnt(12)
  v_dot2c_f32_bf16 v216, v128, v241
  v_dot2c_f32_bf16 v217, v128, v245
  v_dot2c_f32_bf16 v218, v129, v241
  v_dot2c_f32_bf16 v219, v129, v245
  v_dot2c_f32_bf16 v220, v130, v241
  v_dot2c_f32_bf16 v221, v130, v245
  v_dot2c_f32_bf16 v222, v131, v241
  v_dot2c_f32_bf16 v223, v131, v245
  v_dot2c_f32_bf16 v216, v132, v242
  v_dot2c_f32_bf16 v217, v132, v246
  v_dot2c_f32_bf16 v218, v133, v242
  v_dot2c_f32_bf16 v219, v133, v246
  v_dot2c_f32_bf16 v220, v134, v242
  v_dot2c_f32_bf16 v221, v134, v246
  v_dot2c_f32_bf16 v222, v135, v242
  v_dot2c_f32_bf16 v223, v135, v246
  v_dot2c_f32_bf16 v216, v136, v243
  v_dot2c_f32_bf16 v217, v136, v247
  v_dot2c_f32_bf16 v218, v137, v243
  v_dot2c_f32_bf16 v219, v137, v247
  v_dot2c_f32_bf16 v220, v138, v243
  v_dot2c_f32_bf16 v221, v138, v247
  v_dot2c_f32_bf16 v222, v139, v243
  v_dot2c_f32_bf16 v223, v139, v247
  v_dot2c_f32_bf16 v216, v140, v244
  v_dot2c_f32_bf16 v217, v140, v248
  v_dot2c_f32_bf16 v218, v141, v244
  v_dot2c_f32_bf16 v219, v141, v248
  v_dot2c_f32_bf16 v220, v142, v244
  v_dot2c_f32_bf16 v221, v142, v248
  v_dot2c_f32_bf16 v222, v143, v244
  v_dot2c_f32_bf16 v223, v143, v248
  buffer_load_dwordx4 v[32:35], v2, s[8:11], s74 offen offset:0 nt
  buffer_load_dwordx4 v[36:39], v2, s[8:11], s74 offen offset:256 nt
  buffer_load_dwordx4 v[40:43], v2, s[8:11], s74 offen offset:512 nt
  buffer_load_dwordx4 v[44:47], v2, s[8:11], s74 offen offset:768 nt
  s_waitcnt vmcnt(12)
  v_mfma_f32_16x16x32_bf16 v[224:227], v[144:147], v[200:203], 0
  v_mfma_f32_16x16x32_bf16 v[224:227], v[148:151], v[204:207], v[224:227]
  v_mfma_f32_16x16x32_bf16 v[224:227], v[152:155], v[208:211], v[224:227]
  v_mfma_f32_16x16x32_bf16 v[224:227], v[156:159], v[212:215], v[224:227]
  s_add_u32 s74, s74, 32768
  buffer_load_dwordx4 v[48:51], v1, s[4:7], s74 offen offset:0 nt
  buffer_load_dwordx4 v[52:55], v1, s[4:7], s74 offen offset:64 nt
  buffer_load_dwordx4 v[56:59], v1, s[4:7], s74 offen offset:128 nt
  buffer_load_dwordx4 v[60:63], v1, s[4:7], s74 offen offset:192 nt
  s_nop 2
  v_cvt_pk_bf16_f32 v232, v224, v225
  v_cvt_pk_bf16_f32 v233, v226, v227
  v_lshlrev_b32 v228, 16, v232
  v_and_b32 v229, 0xffff0000, v232
  v_lshlrev_b32 v230, 16, v233
  v_and_b32 v231, 0xffff0000, v233
  v_mul_f32 v228, s99, v228
  v_mul_f32 v229, s99, v229
  v_mul_f32 v230, s99, v230
  v_mul_f32 v231, s99, v231
  v_cvt_pk_bf16_f32 v232, v228, v229
  v_cvt_pk_bf16_f32 v233, v230, v231
  v_lshlrev_b32 v228, 16, v232
  v_and_b32 v229, 0xffff0000, v232
  v_lshlrev_b32 v230, 16, v233
  v_and_b32 v231, 0xffff0000, v233
  v_max3_f32 v6, v228, v229, v7
  v_max3_f32 v6, v230, v231, v6
  v_mov_b32 v234, v6
  s_nop 1
  v_permlane32_swap_b32 v6, v234
  v_max_f32 v6, v6, v234
  v_mov_b32 v234, v6
  s_nop 1
  v_permlane16_swap_b32 v6, v234
  v_max_f32 v6, v6, v234
  v_mul_f32 v235, s98, v6
  v_fma_f32 v236, v7, s98, -v235
  v_fma_f32 v237, v228, s98, -v235
  v_fma_f32 v238, v229, s98, -v235
  v_fma_f32 v239, v230, s98, -v235
  v_fma_f32 v240, v231, s98, -v235
  v_exp_f32 v236, v236
  v_exp_f32 v237, v237
  v_exp_f32 v238, v238
  v_exp_f32 v239, v239
  v_exp_f32 v240, v240
  v_mul_f32 v216, v236, v216
  v_mul_f32 v217, v236, v217
  v_mul_f32 v218, v236, v218
  v_mul_f32 v219, v236, v219
  v_mul_f32 v220, v236, v220
  v_mul_f32 v221, v236, v221
  v_mul_f32 v222, v236, v222
  v_mul_f32 v223, v236, v223
  v_add_f32 v249, v237, v238
  v_add_f32 v234, v239, v240
  v_cvt_pk_bf16_f32 v241, v237, 0
  v_cvt_pk_bf16_f32 v245, 0, v237
  v_cvt_pk_bf16_f32 v242, v238, 0
  v_cvt_pk_bf16_f32 v246, 0, v238
  v_cvt_pk_bf16_f32 v243, v239, 0
  v_cvt_pk_bf16_f32 v247, 0, v239
  v_cvt_pk_bf16_f32 v244, v240, 0
  v_cvt_pk_bf16_f32 v248, 0, v240
  v_add_f32 v249, v249, v234
  v_fma_f32 v4, v4, v236, v249
  s_waitcnt vmcnt(12)
  v_dot2c_f32_bf16 v216, v160, v241
  v_dot2c_f32_bf16 v217, v160, v245
  v_dot2c_f32_bf16 v218, v161, v241
  v_dot2c_f32_bf16 v219, v161, v245
  v_dot2c_f32_bf16 v220, v162, v241
  v_dot2c_f32_bf16 v221, v162, v245
  v_dot2c_f32_bf16 v222, v163, v241
  v_dot2c_f32_bf16 v223, v163, v245
  v_dot2c_f32_bf16 v216, v164, v242
  v_dot2c_f32_bf16 v217, v164, v246
  v_dot2c_f32_bf16 v218, v165, v242
  v_dot2c_f32_bf16 v219, v165, v246
  v_dot2c_f32_bf16 v220, v166, v242
  v_dot2c_f32_bf16 v221, v166, v246
  v_dot2c_f32_bf16 v222, v167, v242
  v_dot2c_f32_bf16 v223, v167, v246
  v_dot2c_f32_bf16 v216, v168, v243
  v_dot2c_f32_bf16 v217, v168, v247
  v_dot2c_f32_bf16 v218, v169, v243
  v_dot2c_f32_bf16 v219, v169, v247
  v_dot2c_f32_bf16 v220, v170, v243
  v_dot2c_f32_bf16 v221, v170, v247
  v_dot2c_f32_bf16 v222, v171, v243
  v_dot2c_f32_bf16 v223, v171, v247
  v_dot2c_f32_bf16 v216, v172, v244
  v_dot2c_f32_bf16 v217, v172, v248
  v_dot2c_f32_bf16 v218, v173, v244
  v_dot2c_f32_bf16 v219, v173, v248
  v_dot2c_f32_bf16 v220, v174, v244
  v_dot2c_f32_bf16 v221, v174, v248
  v_dot2c_f32_bf16 v222, v175, v244
  v_dot2c_f32_bf16 v223, v175, v248
  buffer_load_dwordx4 v[64:67], v2, s[8:11], s74 offen offset:0 nt
  buffer_load_dwordx4 v[68:71], v2, s[8:11], s74 offen offset:256 nt
  buffer_load_dwordx4 v[72:75], v2, s[8:11], s74 offen offset:512 nt
  buffer_load_dwordx4 v[76:79], v2, s[8:11], s74 offen offset:768 nt
  s_waitcnt vmcnt(12)
  v_mfma_f32_16x16x32_bf16 v[224:227], v[16:19], v[200:203], 0
  v_mfma_f32_16x16x32_bf16 v[224:227], v[20:23], v[204:207], v[224:227]
  v_mfma_f32_16x16x32_bf16 v[224:227], v[24:27], v[208:211], v[224:227]
  v_mfma_f32_16x16x32_bf16 v[224:227], v[28:31], v[212:215], v[224:227]
  s_add_u32 s74, s74, 32768
  buffer_load_dwordx4 v[80:83], v1, s[4:7], s74 offen offset:0 nt
  buffer_load_dwordx4 v[84:87], v1, s[4:7], s74 offen offset:64 nt
  buffer_load_dwordx4 v[88:91], v1, s[4:7], s74 offen offset:128 nt
  buffer_load_dwordx4 v[92:95], v1, s[4:7], s74 offen offset:192 nt
  s_nop 2
  v_cvt_pk_bf16_f32 v232, v224, v225
  v_cvt_pk_bf16_f32 v233, v226, v227
  v_lshlrev_b32 v228, 16, v232
  v_and_b32 v229, 0xffff0000, v232
  v_lshlrev_b32 v230, 16, v233
  v_and_b32 v231, 0xffff0000, v233
  v_mul_f32 v228, s99, v228
  v_mul_f32 v229, s99, v229
  v_mul_f32 v230, s99, v230
  v_mul_f32 v231, s99, v231
  v_cvt_pk_bf16_f32 v232, v228, v229
  v_cvt_pk_bf16_f32 v233, v230, v231
  v_lshlrev_b32 v228, 16, v232
  v_and_b32 v229, 0xffff0000, v232
  v_lshlrev_b32 v230, 16, v233
  v_and_b32 v231, 0xffff0000, v233
  v_max3_f32 v7, v228, v229, v6
  v_max3_f32 v7, v230, v231, v7
  v_mov_b32 v234, v7
  s_nop 1
  v_permlane32_swap_b32 v7, v234
  v_max_f32 v7, v7, v234
  v_mov_b32 v234, v7
  s_nop 1
  v_permlane16_swap_b32 v7, v234
  v_max_f32 v7, v7, v234
  v_mul_f32 v235, s98, v7
  v_fma_f32 v236, v6, s98, -v235
  v_fma_f32 v237, v228, s98, -v235
  v_fma_f32 v238, v229, s98, -v235
  v_fma_f32 v239, v230, s98, -v235
  v_fma_f32 v240, v231, s98, -v235
  v_exp_f32 v236, v236
  v_exp_f32 v237, v237
  v_exp_f32 v238, v238
  v_exp_f32 v239, v239
  v_exp_f32 v240, v240
  v_mul_f32 v216, v236, v216
  v_mul_f32 v217, v236, v217
  v_mul_f32 v218, v236, v218
  v_mul_f32 v219, v236, v219
  v_mul_f32 v220, v236, v220
  v_mul_f32 v221, v236, v221
  v_mul_f32 v222, v236, v222
  v_mul_f32 v223, v236, v223
  v_add_f32 v249, v237, v238
  v_add_f32 v234, v239, v240
  v_cvt_pk_bf16_f32 v241, v237, 0
  v_cvt_pk_bf16_f32 v245, 0, v237
  v_cvt_pk_bf16_f32 v242, v238, 0
  v_cvt_pk_bf16_f32 v246, 0, v238
  v_cvt_pk_bf16_f32 v243, v239, 0
  v_cvt_pk_bf16_f32 v247, 0, v239
  v_cvt_pk_bf16_f32 v244, v240, 0
  v_cvt_pk_bf16_f32 v248, 0, v240
  v_add_f32 v249, v249, v234
  v_fma_f32 v4, v4, v236, v249
  s_waitcnt vmcnt(12)
  v_dot2c_f32_bf16 v216, v32, v241
  v_dot2c_f32_bf16 v217, v32, v245
  v_dot2c_f32_bf16 v218, v33, v241
  v_dot2c_f32_bf16 v219, v33, v245
  v_dot2c_f32_bf16 v220, v34, v241
  v_dot2c_f32_bf16 v221, v34, v245
  v_dot2c_f32_bf16 v222, v35, v241
  v_dot2c_f32_bf16 v223, v35, v245
  v_dot2c_f32_bf16 v216, v36, v242
  v_dot2c_f32_bf16 v217, v36, v246
  v_dot2c_f32_bf16 v218, v37, v242
  v_dot2c_f32_bf16 v219, v37, v246
  v_dot2c_f32_bf16 v220, v38, v242
  v_dot2c_f32_bf16 v221, v38, v246
  v_dot2c_f32_bf16 v222, v39, v242
  v_dot2c_f32_bf16 v223, v39, v246
  v_dot2c_f32_bf16 v216, v40, v243
  v_dot2c_f32_bf16 v217, v40, v247
  v_dot2c_f32_bf16 v218, v41, v243
  v_dot2c_f32_bf16 v219, v41, v247
  v_dot2c_f32_bf16 v220, v42, v243
  v_dot2c_f32_bf16 v221, v42, v247
  v_dot2c_f32_bf16 v222, v43, v243
  v_dot2c_f32_bf16 v223, v43, v247
  v_dot2c_f32_bf16 v216, v44, v244
  v_dot2c_f32_bf16 v217, v44, v248
  v_dot2c_f32_bf16 v218, v45, v244
  v_dot2c_f32_bf16 v219, v45, v248
  v_dot2c_f32_bf16 v220, v46, v244
  v_dot2c_f32_bf16 v221, v46, v248
  v_dot2c_f32_bf16 v222, v47, v244
  v_dot2c_f32_bf16 v223, v47, v248
  buffer_load_dwordx4 v[96:99], v2, s[8:11], s74 offen offset:0 nt
  buffer_load_dwordx4 v[100:103], v2, s[8:11], s74 offen offset:256 nt
  buffer_load_dwordx4 v[104:107], v2, s[8:11], s74 offen offset:512 nt
  buffer_load_dwordx4 v[108:111], v2, s[8:11], s74 offen offset:768 nt
  s_waitcnt vmcnt(12)
  v_mfma_f32_16x16x32_bf16 v[224:227], v[48:51], v[200:203], 0
  v_mfma_f32_16x16x32_bf16 v[224:227], v[52:55], v[204:207], v[224:227]
  v_mfma_f32_16x16x32_bf16 v[224:227], v[56:59], v[208:211], v[224:227]
  v_mfma_f32_16x16x32_bf16 v[224:227], v[60:63], v[212:215], v[224:227]
  s_add_u32 s74, s74, 32768
  buffer_load_dwordx4 v[112:115], v1, s[4:7], s74 offen offset:0 nt
  buffer_load_dwordx4 v[116:119], v1, s[4:7], s74 offen offset:64 nt
  buffer_load_dwordx4 v[120:123], v1, s[4:7], s74 offen offset:128 nt
  buffer_load_dwordx4 v[124:127], v1, s[4:7], s74 offen offset:192 nt
  s_nop 2
  v_cvt_pk_bf16_f32 v232, v224, v225
  v_cvt_pk_bf16_f32 v233, v226, v227
  v_lshlrev_b32 v228, 16, v232
  v_and_b32 v229, 0xffff0000, v232
  v_lshlrev_b32 v230, 16, v233
  v_and_b32 v231, 0xffff0000, v233
  v_mul_f32 v228, s99, v228
  v_mul_f32 v229, s99, v229
  v_mul_f32 v230, s99, v230
  v_mul_f32 v231, s99, v231
  v_cvt_pk_bf16_f32 v232, v228, v229
  v_cvt_pk_bf16_f32 v233, v230, v231
  v_lshlrev_b32 v228, 16, v232
  v_and_b32 v229, 0xffff0000, v232
  v_lshlrev_b32 v230, 16, v233
  v_and_b32 v231, 0xffff0000, v233
  v_max3_f32 v6, v228, v229, v7
  v_max3_f32 v6, v230, v231, v6
  v_mov_b32 v234, v6
  s_nop 1
  v_permlane32_swap_b32 v6, v234
  v_max_f32 v6, v6, v234
  v_mov_b32 v234, v6
  s_nop 1
  v_permlane16_swap_b32 v6, v234
  v_max_f32 v6, v6, v234
  v_mul_f32 v235, s98, v6
  v_fma_f32 v236, v7, s98, -v235
  v_fma_f32 v237, v228, s98, -v235
  v_fma_f32 v238, v229, s98, -v235
  v_fma_f32 v239, v230, s98, -v235
  v_fma_f32 v240, v231, s98, -v235
  v_exp_f32 v236, v236
  v_exp_f32 v237, v237
  v_exp_f32 v238, v238
  v_exp_f32 v239, v239
  v_exp_f32 v240, v240
  v_mul_f32 v216, v236, v216
  v_mul_f32 v217, v236, v217
  v_mul_f32 v218, v236, v218
  v_mul_f32 v219, v236, v219
  v_mul_f32 v220, v236, v220
  v_mul_f32 v221, v236, v221
  v_mul_f32 v222, v236, v222
  v_mul_f32 v223, v236, v223
  v_add_f32 v249, v237, v238
  v_add_f32 v234, v239, v240
  v_cvt_pk_bf16_f32 v241, v237, 0
  v_cvt_pk_bf16_f32 v245, 0, v237
  v_cvt_pk_bf16_f32 v242, v238, 0
  v_cvt_pk_bf16_f32 v246, 0, v238
  v_cvt_pk_bf16_f32 v243, v239, 0
  v_cvt_pk_bf16_f32 v247, 0, v239
  v_cvt_pk_bf16_f32 v244, v240, 0
  v_cvt_pk_bf16_f32 v248, 0, v240
  v_add_f32 v249, v249, v234
  v_fma_f32 v4, v4, v236, v249
  s_waitcnt vmcnt(12)
  v_dot2c_f32_bf16 v216, v64, v241
  v_dot2c_f32_bf16 v217, v64, v245
  v_dot2c_f32_bf16 v218, v65, v241
  v_dot2c_f32_bf16 v219, v65, v245
  v_dot2c_f32_bf16 v220, v66, v241
  v_dot2c_f32_bf16 v221, v66, v245
  v_dot2c_f32_bf16 v222, v67, v241
  v_dot2c_f32_bf16 v223, v67, v245
  v_dot2c_f32_bf16 v216, v68, v242
  v_dot2c_f32_bf16 v217, v68, v246
  v_dot2c_f32_bf16 v218, v69, v242
  v_dot2c_f32_bf16 v219, v69, v246
  v_dot2c_f32_bf16 v220, v70, v242
  v_dot2c_f32_bf16 v221, v70, v246
  v_dot2c_f32_bf16 v222, v71, v242
  v_dot2c_f32_bf16 v223, v71, v246
  v_dot2c_f32_bf16 v216, v72, v243
  v_dot2c_f32_bf16 v217, v72, v247
  v_dot2c_f32_bf16 v218, v73, v243
  v_dot2c_f32_bf16 v219, v73, v247
  v_dot2c_f32_bf16 v220, v74, v243
  v_dot2c_f32_bf16 v221, v74, v247
  v_dot2c_f32_bf16 v222, v75, v243
  v_dot2c_f32_bf16 v223, v75, v247
  v_dot2c_f32_bf16 v216, v76, v244
  v_dot2c_f32_bf16 v217, v76, v248
  v_dot2c_f32_bf16 v218, v77, v244
  v_dot2c_f32_bf16 v219, v77, v248
  v_dot2c_f32_bf16 v220, v78, v244
  v_dot2c_f32_bf16 v221, v78, v248
  v_dot2c_f32_bf16 v222, v79, v244
  v_dot2c_f32_bf16 v223, v79, v248
  buffer_load_dwordx4 v[128:131], v2, s[8:11], s74 offen offset:0 nt
  buffer_load_dwordx4 v[132:135], v2, s[8:11], s74 offen offset:256 nt
  buffer_load_dwordx4 v[136:139], v2, s[8:11], s74 offen offset:512 nt
  buffer_load_dwordx4 v[140:143], v2, s[8:11], s74 offen offset:768 nt
  s_waitcnt vmcnt(12)
  v_mfma_f32_16x16x32_bf16 v[224:227], v[80:83], v[200:203], 0
  v_mfma_f32_16x16x32_bf16 v[224:227], v[84:87], v[204:207], v[224:227]
  v_mfma_f32_16x16x32_bf16 v[224:227], v[88:91], v[208:211], v[224:227]
  v_mfma_f32_16x16x32_bf16 v[224:227], v[92:95], v[212:215], v[224:227]
  s_add_u32 s74, s74, 32768
  buffer_load_dwordx4 v[144:147], v1, s[4:7], s74 offen offset:0 nt
  buffer_load_dwordx4 v[148:151], v1, s[4:7], s74 offen offset:64 nt
  buffer_load_dwordx4 v[152:155], v1, s[4:7], s74 offen offset:128 nt
  buffer_load_dwordx4 v[156:159], v1, s[4:7], s74 offen offset:192 nt
  s_nop 2
  v_cvt_pk_bf16_f32 v232, v224, v225
  v_cvt_pk_bf16_f32 v233, v226, v227
  v_lshlrev_b32 v228, 16, v232
  v_and_b32 v229, 0xffff0000, v232
  v_lshlrev_b32 v230, 16, v233
  v_and_b32 v231, 0xffff0000, v233
  v_mul_f32 v228, s99, v228
  v_mul_f32 v229, s99, v229
  v_mul_f32 v230, s99, v230
  v_mul_f32 v231, s99, v231
  v_cvt_pk_bf16_f32 v232, v228, v229
  v_cvt_pk_bf16_f32 v233, v230, v231
  v_lshlrev_b32 v228, 16, v232
  v_and_b32 v229, 0xffff0000, v232
  v_lshlrev_b32 v230, 16, v233
  v_and_b32 v231, 0xffff0000, v233
  v_max3_f32 v7, v228, v229, v6
  v_max3_f32 v7, v230, v231, v7
  v_mov_b32 v234, v7
  s_nop 1
  v_permlane32_swap_b32 v7, v234
  v_max_f32 v7, v7, v234
  v_mov_b32 v234, v7
  s_nop 1
  v_permlane16_swap_b32 v7, v234
  v_max_f32 v7, v7, v234
  v_mul_f32 v235, s98, v7
  v_fma_f32 v236, v6, s98, -v235
  v_fma_f32 v237, v228, s98, -v235
  v_fma_f32 v238, v229, s98, -v235
  v_fma_f32 v239, v230, s98, -v235
  v_fma_f32 v240, v231, s98, -v235
  v_exp_f32 v236, v236
  v_exp_f32 v237, v237
  v_exp_f32 v238, v238
  v_exp_f32 v239, v239
  v_exp_f32 v240, v240
  v_mul_f32 v216, v236, v216
  v_mul_f32 v217, v236, v217
  v_mul_f32 v218, v236, v218
  v_mul_f32 v219, v236, v219
  v_mul_f32 v220, v236, v220
  v_mul_f32 v221, v236, v221
  v_mul_f32 v222, v236, v222
  v_mul_f32 v223, v236, v223
  v_add_f32 v249, v237, v238
  v_add_f32 v234, v239, v240
  v_cvt_pk_bf16_f32 v241, v237, 0
  v_cvt_pk_bf16_f32 v245, 0, v237
  v_cvt_pk_bf16_f32 v242, v238, 0
  v_cvt_pk_bf16_f32 v246, 0, v238
  v_cvt_pk_bf16_f32 v243, v239, 0
  v_cvt_pk_bf16_f32 v247, 0, v239
  v_cvt_pk_bf16_f32 v244, v240, 0
  v_cvt_pk_bf16_f32 v248, 0, v240
  v_add_f32 v249, v249, v234
  v_fma_f32 v4, v4, v236, v249
  s_waitcnt vmcnt(12)
  v_dot2c_f32_bf16 v216, v96, v241
  v_dot2c_f32_bf16 v217, v96, v245
  v_dot2c_f32_bf16 v218, v97, v241
  v_dot2c_f32_bf16 v219, v97, v245
  v_dot2c_f32_bf16 v220, v98, v241
  v_dot2c_f32_bf16 v221, v98, v245
  v_dot2c_f32_bf16 v222, v99, v241
  v_dot2c_f32_bf16 v223, v99, v245
  v_dot2c_f32_bf16 v216, v100, v242
  v_dot2c_f32_bf16 v217, v100, v246
  v_dot2c_f32_bf16 v218, v101, v242
  v_dot2c_f32_bf16 v219, v101, v246
  v_dot2c_f32_bf16 v220, v102, v242
  v_dot2c_f32_bf16 v221, v102, v246
  v_dot2c_f32_bf16 v222, v103, v242
  v_dot2c_f32_bf16 v223, v103, v246
  v_dot2c_f32_bf16 v216, v104, v243
  v_dot2c_f32_bf16 v217, v104, v247
  v_dot2c_f32_bf16 v218, v105, v243
  v_dot2c_f32_bf16 v219, v105, v247
  v_dot2c_f32_bf16 v220, v106, v243
  v_dot2c_f32_bf16 v221, v106, v247
  v_dot2c_f32_bf16 v222, v107, v243
  v_dot2c_f32_bf16 v223, v107, v247
  v_dot2c_f32_bf16 v216, v108, v244
  v_dot2c_f32_bf16 v217, v108, v248
  v_dot2c_f32_bf16 v218, v109, v244
  v_dot2c_f32_bf16 v219, v109, v248
  v_dot2c_f32_bf16 v220, v110, v244
  v_dot2c_f32_bf16 v221, v110, v248
  v_dot2c_f32_bf16 v222, v111, v244
  v_dot2c_f32_bf16 v223, v111, v248
  buffer_load_dwordx4 v[160:163], v2, s[8:11], s74 offen offset:0 nt
  buffer_load_dwordx4 v[164:167], v2, s[8:11], s74 offen offset:256 nt
  buffer_load_dwordx4 v[168:171], v2, s[8:11], s74 offen offset:512 nt
  buffer_load_dwordx4 v[172:175], v2, s[8:11], s74 offen offset:768 nt
  s_waitcnt vmcnt(12)
  v_mfma_f32_16x16x32_bf16 v[224:227], v[112:115], v[200:203], 0
  v_mfma_f32_16x16x32_bf16 v[224:227], v[116:119], v[204:207], v[224:227]
  v_mfma_f32_16x16x32_bf16 v[224:227], v[120:123], v[208:211], v[224:227]
  v_mfma_f32_16x16x32_bf16 v[224:227], v[124:127], v[212:215], v[224:227]
  s_add_u32 s74, s74, 32768
  buffer_load_dwordx4 v[16:19], v1, s[4:7], s74 offen offset:0 nt
  buffer_load_dwordx4 v[20:23], v1, s[4:7], s74 offen offset:64 nt
  buffer_load_dwordx4 v[24:27], v1, s[4:7], s74 offen offset:128 nt
  buffer_load_dwordx4 v[28:31], v1, s[4:7], s74 offen offset:192 nt
  s_nop 2
  v_cvt_pk_bf16_f32 v232, v224, v225
  v_cvt_pk_bf16_f32 v233, v226, v227
  v_lshlrev_b32 v228, 16, v232
  v_and_b32 v229, 0xffff0000, v232
  v_lshlrev_b32 v230, 16, v233
  v_and_b32 v231, 0xffff0000, v233
  v_mul_f32 v228, s99, v228
  v_mul_f32 v229, s99, v229
  v_mul_f32 v230, s99, v230
  v_mul_f32 v231, s99, v231
  v_cvt_pk_bf16_f32 v232, v228, v229
  v_cvt_pk_bf16_f32 v233, v230, v231
  v_lshlrev_b32 v228, 16, v232
  v_and_b32 v229, 0xffff0000, v232
  v_lshlrev_b32 v230, 16, v233
  v_and_b32 v231, 0xffff0000, v233
  v_max3_f32 v6, v228, v229, v7
  v_max3_f32 v6, v230, v231, v6
  v_mov_b32 v234, v6
  s_nop 1
  v_permlane32_swap_b32 v6, v234
  v_max_f32 v6, v6, v234
  v_mov_b32 v234, v6
  s_nop 1
  v_permlane16_swap_b32 v6, v234
  v_max_f32 v6, v6, v234
  v_mul_f32 v235, s98, v6
  v_fma_f32 v236, v7, s98, -v235
  v_fma_f32 v237, v228, s98, -v235
  v_fma_f32 v238, v229, s98, -v235
  v_fma_f32 v239, v230, s98, -v235
  v_fma_f32 v240, v231, s98, -v235
  v_exp_f32 v236, v236
  v_exp_f32 v237, v237
  v_exp_f32 v238, v238
  v_exp_f32 v239, v239
  v_exp_f32 v240, v240
  v_mul_f32 v216, v236, v216
  v_mul_f32 v217, v236, v217
  v_mul_f32 v218, v236, v218
  v_mul_f32 v219, v236, v219
  v_mul_f32 v220, v236, v220
  v_mul_f32 v221, v236, v221
  v_mul_f32 v222, v236, v222
  v_mul_f32 v223, v236, v223
  v_add_f32 v249, v237, v238
  v_add_f32 v234, v239, v240
  v_cvt_pk_bf16_f32 v241, v237, 0
  v_cvt_pk_bf16_f32 v245, 0, v237
  v_cvt_pk_bf16_f32 v242, v238, 0
  v_cvt_pk_bf16_f32 v246, 0, v238
  v_cvt_pk_bf16_f32 v243, v239, 0
  v_cvt_pk_bf16_f32 v247, 0, v239
  v_cvt_pk_bf16_f32 v244, v240, 0
  v_cvt_pk_bf16_f32 v248, 0, v240
  v_add_f32 v249, v249, v234
  v_fma_f32 v4, v4, v236, v249
  s_waitcnt vmcnt(12)
  v_dot2c_f32_bf16 v216, v128, v241
  v_dot2c_f32_bf16 v217, v128, v245
  v_dot2c_f32_bf16 v218, v129, v241
  v_dot2c_f32_bf16 v219, v129, v245
  v_dot2c_f32_bf16 v220, v130, v241
  v_dot2c_f32_bf16 v221, v130, v245
  v_dot2c_f32_bf16 v222, v131, v241
  v_dot2c_f32_bf16 v223, v131, v245
  v_dot2c_f32_bf16 v216, v132, v242
  v_dot2c_f32_bf16 v217, v132, v246
  v_dot2c_f32_bf16 v218, v133, v242
  v_dot2c_f32_bf16 v219, v133, v246
  v_dot2c_f32_bf16 v220, v134, v242
  v_dot2c_f32_bf16 v221, v134, v246
  v_dot2c_f32_bf16 v222, v135, v242
  v_dot2c_f32_bf16 v223, v135, v246
  v_dot2c_f32_bf16 v216, v136, v243
  v_dot2c_f32_bf16 v217, v136, v247
  v_dot2c_f32_bf16 v218, v137, v243
  v_dot2c_f32_bf16 v219, v137, v247
  v_dot2c_f32_bf16 v220, v138, v243
  v_dot2c_f32_bf16 v221, v138, v247
  v_dot2c_f32_bf16 v222, v139, v243
  v_dot2c_f32_bf16 v223, v139, v247
  v_dot2c_f32_bf16 v216, v140, v244
  v_dot2c_f32_bf16 v217, v140, v248
  v_dot2c_f32_bf16 v218, v141, v244
  v_dot2c_f32_bf16 v219, v141, v248
  v_dot2c_f32_bf16 v220, v142, v244
  v_dot2c_f32_bf16 v221, v142, v248
  v_dot2c_f32_bf16 v222, v143, v244
  v_dot2c_f32_bf16 v223, v143, v248
  buffer_load_dwordx4 v[32:35], v2, s[8:11], s74 offen offset:0 nt
  buffer_load_dwordx4 v[36:39], v2, s[8:11], s74 offen offset:256 nt
  buffer_load_dwordx4 v[40:43], v2, s[8:11], s74 offen offset:512 nt
  buffer_load_dwordx4 v[44:47], v2, s[8:11], s74 offen offset:768 nt
  s_cmp_lt_u32 s70, 4
  s_cbranch_scc1 L_nbar13
  s_barrier
L_nbar13:
  s_waitcnt vmcnt(12)
  v_mfma_f32_16x16x32_bf16 v[224:227], v[144:147], v[200:203], 0
  v_mfma_f32_16x16x32_bf16 v[224:227], v[148:151], v[204:207], v[224:227]
  v_mfma_f32_16x16x32_bf16 v[224:227], v[152:155], v[208:211], v[224:227]
  v_mfma_f32_16x16x32_bf16 v[224:227], v[156:159], v[212:215], v[224:227]
  s_nop 7
  v_cvt_pk_bf16_f32 v232, v224, v225
  v_cvt_pk_bf16_f32 v233, v226, v227
  v_lshlrev_b32 v228, 16, v232
  v_and_b32 v229, 0xffff0000, v232
  v_lshlrev_b32 v230, 16, v233
  v_and_b32 v231, 0xffff0000, v233
  v_mul_f32 v228, s99, v228
  v_mul_f32 v229, s99, v229
  v_mul_f32 v230, s99, v230
  v_mul_f32 v231, s99, v231
  v_cvt_pk_bf16_f32 v232, v228, v229
  v_cvt_pk_bf16_f32 v233, v230, v231
  v_lshlrev_b32 v228, 16, v232
  v_and_b32 v229, 0xffff0000, v232
  v_lshlrev_b32 v230, 16, v233
  v_and_b32 v231, 0xffff0000, v233
  v_max3_f32 v7, v228, v229, v6
  v_max3_f32 v7, v230, v231, v7
  v_mov_b32 v234, v7
  s_nop 1
  v_permlane32_swap_b32 v7, v234
  v_max_f32 v7, v7, v234
  v_mov_b32 v234, v7
  s_nop 1
  v_permlane16_swap_b32 v7, v234
  v_max_f32 v7, v7, v234
  v_mul_f32 v235, s98, v7
  v_fma_f32 v236, v6, s98, -v235
  v_fma_f32 v237, v228, s98, -v235
  v_fma_f32 v238, v229, s98, -v235
  v_fma_f32 v239, v230, s98, -v235
  v_fma_f32 v240, v231, s98, -v235
  v_exp_f32 v236, v236
  v_exp_f32 v237, v237
  v_exp_f32 v238, v238
  v_exp_f32 v239, v239
  v_exp_f32 v240, v240
  v_mul_f32 v216, v236, v216
  v_mul_f32 v217, v236, v217
  v_mul_f32 v218, v236, v218
  v_mul_f32 v219, v236, v219
  v_mul_f32 v220, v236, v220
  v_mul_f32 v221, v236, v221
  v_mul_f32 v222, v236, v222
  v_mul_f32 v223, v236, v223
  v_add_f32 v249, v237, v238
  v_add_f32 v234, v239, v240
  v_cvt_pk_bf16_f32 v241, v237, 0
  v_cvt_pk_bf16_f32 v245, 0, v237
  v_cvt_pk_bf16_f32 v242, v238, 0
  v_cvt_pk_bf16_f32 v246, 0, v238
  v_cvt_pk_bf16_f32 v243, v239, 0
  v_cvt_pk_bf16_f32 v247, 0, v239
  v_cvt_pk_bf16_f32 v244, v240, 0
  v_cvt_pk_bf16_f32 v248, 0, v240
  v_add_f32 v249, v249, v234
  v_fma_f32 v4, v4, v236, v249
  s_waitcnt vmcnt(8)
  v_dot2c_f32_bf16 v216, v160, v241
  v_dot2c_f32_bf16 v217, v160, v245
  v_dot2c_f32_bf16 v218, v161, v241
  v_dot2c_f32_bf16 v219, v161, v245
  v_dot2c_f32_bf16 v220, v162, v241
  v_dot2c_f32_bf16 v221, v162, v245
  v_dot2c_f32_bf16 v222, v163, v241
  v_dot2c_f32_bf16 v223, v163, v245
  v_dot2c_f32_bf16 v216, v164, v242
  v_dot2c_f32_bf16 v217, v164, v246
  v_dot2c_f32_bf16 v218, v165, v242
  v_dot2c_f32_bf16 v219, v165, v246
  v_dot2c_f32_bf16 v220, v166, v242
  v_dot2c_f32_bf16 v221, v166, v246
  v_dot2c_f32_bf16 v222, v167, v242
  v_dot2c_f32_bf16 v223, v167, v246
  v_dot2c_f32_bf16 v216, v168, v243
  v_dot2c_f32_bf16 v217, v168, v247
  v_dot2c_f32_bf16 v218, v169, v243
  v_dot2c_f32_bf16 v219, v169, v247
  v_dot2c_f32_bf16 v220, v170, v243
  v_dot2c_f32_bf16 v221, v170, v247
  v_dot2c_f32_bf16 v222, v171, v243
  v_dot2c_f32_bf16 v223, v171, v247
  v_dot2c_f32_bf16 v216, v172, v244
  v_dot2c_f32_bf16 v217, v172, v248
  v_dot2c_f32_bf16 v218, v173, v244
  v_dot2c_f32_bf16 v219, v173, v248
  v_dot2c_f32_bf16 v220, v174, v244
  v_dot2c_f32_bf16 v221, v174, v248
  v_dot2c_f32_bf16 v222, v175, v244
  v_dot2c_f32_bf16 v223, v175, v248
  s_waitcnt vmcnt(4)
  v_mfma_f32_16x16x32_bf16 v[224:227], v[16:19], v[200:203], 0
  v_mfma_f32_16x16x32_bf16 v[224:227], v[20:23], v[204:207], v[224:227]
  v_mfma_f32_16x16x32_bf16 v[224:227], v[24:27], v[208:211], v[224:227]
  v_mfma_f32_16x16x32_bf16 v[224:227], v[28:31], v[212:215], v[224:227]
  s_nop 7
  v_cvt_pk_bf16_f32 v232, v224, v225
  v_cvt_pk_bf16_f32 v233, v226, v227
  v_lshlrev_b32 v228, 16, v232
  v_and_b32 v229, 0xffff0000, v232
  v_lshlrev_b32 v230, 16, v233
  v_and_b32 v231, 0xffff0000, v233
  v_mul_f32 v228, s99, v228
  v_mul_f32 v229, s99, v229
  v_mul_f32 v230, s99, v230
  v_mul_f32 v231, s99, v231
  v_cvt_pk_bf16_f32 v232, v228, v229
  v_cvt_pk_bf16_f32 v233, v230, v231
  v_lshlrev_b32 v228, 16, v232
  v_and_b32 v229, 0xffff0000, v232
  v_lshlrev_b32 v230, 16, v233
  v_and_b32 v231, 0xffff0000, v233
  v_max3_f32 v6, v228, v229, v7
  v_max3_f32 v6, v230, v231, v6
  v_mov_b32 v234, v6
  s_nop 1
  v_permlane32_swap_b32 v6, v234
  v_max_f32 v6, v6, v234
  v_mov_b32 v234, v6
  s_nop 1
  v_permlane16_swap_b32 v6, v234
  v_max_f32 v6, v6, v234
  v_mul_f32 v235, s98, v6
  v_fma_f32 v236, v7, s98, -v235
  v_fma_f32 v237, v228, s98, -v235
  v_fma_f32 v238, v229, s98, -v235
  v_fma_f32 v239, v230, s98, -v235
  v_fma_f32 v240, v231, s98, -v235
  v_exp_f32 v236, v236
  v_exp_f32 v237, v237
  v_exp_f32 v238, v238
  v_exp_f32 v239, v239
  v_exp_f32 v240, v240
  v_mul_f32 v216, v236, v216
  v_mul_f32 v217, v236, v217
  v_mul_f32 v218, v236, v218
  v_mul_f32 v219, v236, v219
  v_mul_f32 v220, v236, v220
  v_mul_f32 v221, v236, v221
  v_mul_f32 v222, v236, v222
  v_mul_f32 v223, v236, v223
  v_add_f32 v249, v237, v238
  v_add_f32 v234, v239, v240
  v_cvt_pk_bf16_f32 v241, v237, 0
  v_cvt_pk_bf16_f32 v245, 0, v237
  v_cvt_pk_bf16_f32 v242, v238, 0
  v_cvt_pk_bf16_f32 v246, 0, v238
  v_cvt_pk_bf16_f32 v243, v239, 0
  v_cvt_pk_bf16_f32 v247, 0, v239
  v_cvt_pk_bf16_f32 v244, v240, 0
  v_cvt_pk_bf16_f32 v248, 0, v240
  v_add_f32 v249, v249, v234
  v_fma_f32 v4, v4, v236, v249
  v_mov_b32 v234, v4
  s_nop 1
  v_permlane32_swap_b32 v4, v234
  v_add_f32 v4, v4, v234
  v_mov_b32 v234, v4
  s_nop 1
  v_permlane16_swap_b32 v4, v234
  v_add_f32 v4, v4, v234
  v_mov_b32 v255, s3
  v_cndmask_b32_e64 v254, v6, v4, s[84:85]
  s_waitcnt vmcnt(0)
  v_dot2c_f32_bf16 v216, v32, v241
  v_dot2c_f32_bf16 v217, v32, v245
  v_dot2c_f32_bf16 v218, v33, v241
  v_dot2c_f32_bf16 v219, v33, v245
  v_dot2c_f32_bf16 v220, v34, v241
  v_dot2c_f32_bf16 v221, v34, v245
  v_dot2c_f32_bf16 v222, v35, v241
  v_dot2c_f32_bf16 v223, v35, v245
  v_dot2c_f32_bf16 v216, v36, v242
  v_dot2c_f32_bf16 v217, v36, v246
  v_dot2c_f32_bf16 v218, v37, v242
  v_dot2c_f32_bf16 v219, v37, v246
  v_dot2c_f32_bf16 v220, v38, v242
  v_dot2c_f32_bf16 v221, v38, v246
  v_dot2c_f32_bf16 v222, v39, v242
  v_dot2c_f32_bf16 v223, v39, v246
  v_dot2c_f32_bf16 v216, v40, v243
  v_dot2c_f32_bf16 v217, v40, v247
  v_dot2c_f32_bf16 v218, v41, v243
  v_dot2c_f32_bf16 v219, v41, v247
  v_dot2c_f32_bf16 v220, v42, v243
  v_dot2c_f32_bf16 v221, v42, v247
  v_dot2c_f32_bf16 v222, v43, v243
  v_dot2c_f32_bf16 v223, v43, v247
  v_dot2c_f32_bf16 v216, v44, v244
  v_dot2c_f32_bf16 v217, v44, v248
  v_dot2c_f32_bf16 v218, v45, v244
  v_dot2c_f32_bf16 v219, v45, v248
  v_dot2c_f32_bf16 v220, v46, v244
  v_dot2c_f32_bf16 v221, v46, v248
  v_dot2c_f32_bf16 v222, v47, v244
  v_dot2c_f32_bf16 v223, v47, v248
  s_cmp_lt_u32 s70, 4
  s_cbranch_scc1 L_Ptail
  v_permlane32_swap_b32 v216, v220
  v_permlane32_swap_b32 v217, v221
  v_permlane32_swap_b32 v218, v222
  v_permlane32_swap_b32 v219, v223
  v_add_f32 v216, v216, v220
  v_add_f32 v217, v217, v221
  v_add_f32 v218, v218, v222
  v_add_f32 v219, v219, v223
  s_nop 0
  v_permlane16_swap_b32 v216, v218
  v_permlane16_swap_b32 v217, v219
  v_add_f32 v252, v216, v218
  v_add_f32 v253, v217, v219
  s_cmp_eq_u32 s95, 0
  s_cbranch_scc1 L_recfar
  buffer_store_dwordx4 v[252:255], v5, s[28:31], s94 offen
  s_branch L_recdone
L_recfar:
  buffer_store_dwordx4 v[252:255], v5, s[28:31], s94 offen sc1
L_recdone:
  s_barrier
  s_barrier
  s_branch L_fin
L_Ptail:
  s_mul_i32 s75, s70, 3072
  s_add_u32 s75, s75, 18688
  v_add_u32 v228, s75, v3
  v_mov_b32 v230, v6
  v_mov_b32 v231, v4
  ds_write_b128 v228, v[216:219]
  ds_write_b128 v228, v[220:223] offset:1024
  ds_write_b64 v228, v[230:231] offset:2048
  s_lshl_b32 s75, s72, 2
  s_add_u32 s75, s75, s81
  s_mul_i32 s77, s82, 640
  s_mul_i32 s76, s75, 40960
  s_add_u32 s76, s76, s77
  s_add_u32 s16, s52, s76
  s_addc_u32 s17, s53, 0
  s_and_b32 s17, s17, 0xffff
  s_mov_b32 s18, 40320
  s_mov_b32 s19, 0x20000
  s_mul_i32 s76, s70, 10240
  s_add_u32 s77, s76, 5120
  s_mov_b32 exec_hi, 0xff
  buffer_load_dwordx4 v[16:19], v3, s[16:19], s76 offen offset:0 nt
  buffer_load_dwordx4 v[20:23], v3, s[16:19], s76 offen offset:1280 nt
  buffer_load_dwordx4 v[24:27], v3, s[16:19], s76 offen offset:2560 nt
  buffer_load_dwordx4 v[28:31], v3, s[16:19], s76 offen offset:3840 nt
  buffer_load_dwordx4 v[32:35], v3, s[16:19], s77 offen offset:0 nt
  buffer_load_dwordx4 v[36:39], v3, s[16:19], s77 offen offset:1280 nt
  buffer_load_dwordx4 v[40:43], v3, s[16:19], s77 offen offset:2560 nt
  buffer_load_dwordx4 v[44:47], v3, s[16:19], s77 offen offset:3840 nt
  s_mov_b64 exec, -1
  s_lshl_b32 s76, s82, 7
  s_add_u32 s75, s75, s76
  s_mul_i32 s79, s75, 1920
  s_lshl_b32 s76, s70, 9
  s_add_u32 s79, s79, s76
  s_add_u32 s79, s79, 1377280
  v_add_u32 v51, s76, v3
  s_mul_i32 s76, s70, 1920
  v_mul_u32_u24 v50, 48, v0
  v_add_u32 v50, s76, v50
  v_mov_b32 v119, s3
  v_mov_b32 v54, s98
  s_waitcnt lgkmcnt(0)
  s_barrier
  s_add_u32 s76, s79, 491520
  s_cmp_eq_u32 s70, 3
  s_cselect_b32 s77, 0x00ffffff, -1
  s_mov_b32 exec_lo, s77
  s_mov_b32 exec_hi, 0
  ds_read_b128 v[100:103], v51 offset:10752
  ds_read_b128 v[104:107], v51 offset:12672
  ds_read_b128 v[108:111], v51 offset:14592
  ds_read_b128 v[112:115], v51 offset:16512
  s_waitcnt lgkmcnt(2)
  v_pk_add_f32 v[100:101], v[100:101], v[104:105]
  v_add_f32 v102, v102, v106
  s_waitcnt lgkmcnt(0)
  v_pk_add_f32 v[108:109], v[108:109], v[112:113]
  v_add_f32 v110, v110, v114
  v_pk_add_f32 v[116:117], v[100:101], v[108:109]
  v_add_f32 v118, v102, v110
  buffer_store_dwordx4 v[116:119], v3, s[28:31], s76 offen sc1
  s_mov_b64 exec, -1
  s_and_b32 s75, s2, 7
  s_lshr_b32 s76, s2, 6
  s_lshl_b32 s76, s76, 3
  s_add_u32 s75, s75, s76
  s_cmp_lt_u32 s75, 30
  s_cselect_b32 s80, 0, 4
  s_cmp_eq_u32 s70, 0
  s_cselect_b32 s80, s80, 4
  s_min_u32 s75, s75, 29
  s_cmp_ge_u32 s75, 15
  s_cselect_b32 s76, 1, 0
  s_mul_i32 s77, s76, 15
  s_sub_u32 s75, s75, s77
  s_lshl_b32 s75, s75, 3
  s_bfe_u32 s77, s2, 196611
  s_add_u32 s75, s75, s77
  s_mul_i32 s54, s76, 245760
  s_lshl_b32 s77, s75, 4
  s_add_u32 s54, s54, s77
  s_add_u32 s54, s54, 1377280
  s_add_u32 s55, s54, 122880
  s_mul_i32 s77, s75, 171
  s_lshr_b32 s77, s77, 9
  s_mul_i32 s78, s77, 3
  s_sub_u32 s78, s75, s78
  s_add_u32 s80, s80, s78
  s_mul_i32 s76, s76, 320
  s_lshl_b32 s77, s77, 3
  s_add_u32 s76, s76, s77
  s_mul_i32 s78, s78, 3
  s_add_u32 s76, s76, s78
  v_and_b32 v53, 1, v9
  v_lshrrev_b32 v84, 1, v9
  v_lshl_add_u32 v53, v53, 1, v84
  v_add_u32 v53, s76, v53
  v_min_u32 v53, 639, v53
  v_lshlrev_b32 v53, 1, v53
  v_mul_u32_u24 v52, 1920, v0
  s_cmp_lt_u32 s80, 4
  s_cbranch_scc0 L_nofx
  global_load_ushort v55, v53, s[44:45]
  global_load_ushort v56, v53, s[62:63]
L_nofx:
  s_waitcnt vmcnt(0)
  v_perm_b32 v48, v20, v16, s96
  v_perm_b32 v20, v20, v16, s97
  v_perm_b32 v16, v21, v17, s96
  v_perm_b32 v21, v21, v17, s97
  v_perm_b32 v17, v22, v18, s96
  v_perm_b32 v22, v22, v18, s97
  v_perm_b32 v18, v23, v19, s96
  v_perm_b32 v23, v23, v19, s97
  v_perm_b32 v19, v28, v24, s96
  v_perm_b32 v28, v28, v24, s97
  v_perm_b32 v24, v29, v25, s96
  v_perm_b32 v29, v29, v25, s97
  v_perm_b32 v25, v30, v26, s96
  v_perm_b32 v30, v30, v26, s97
  v_perm_b32 v26, v31, v27, s96
  v_perm_b32 v31, v31, v27, s97
  v_perm_b32 v27, v36, v32, s96
  v_perm_b32 v36, v36, v32, s97
  v_perm_b32 v32, v37, v33, s96
  v_perm_b32 v37, v37, v33, s97
  v_perm_b32 v33, v38, v34, s96
  v_perm_b32 v38, v38, v34, s97
  v_perm_b32 v34, v39, v35, s96
  v_perm_b32 v39, v39, v35, s97
  v_perm_b32 v35, v44, v40, s96
  v_perm_b32 v44, v44, v40, s97
  v_perm_b32 v40, v45, v41, s96
  v_perm_b32 v45, v45, v41, s97
  v_perm_b32 v41, v46, v42, s96
  v_perm_b32 v46, v46, v42, s97
  v_perm_b32 v42, v47, v43, s96
  v_perm_b32 v47, v47, v43, s97
  s_mov_b32 s40, s64
  s_and_b32 s41, s65, 0xffff
  s_mov_b32 s42, 1280
  s_mov_b32 s43, 0x20000
  s_mul_i32 s94, s72, 16
  s_lshl_b32 s75, s81, 2
  s_add_u32 s94, s94, s75
  s_add_u32 s94, s94, s70
  s_mul_i32 s94, s94, 2176
  s_add_u32 s94, s94, 263168
  s_barrier
  s_cmp_lt_u32 s80, 4
  s_cbranch_scc0 L_nobg
  s_add_u32 s75, s54, 491520
  s_add_u32 s76, s55, 491520
  buffer_load_dwordx4 v[128:131], v52, s[28:31], s75 offen sc1
  buffer_load_dwordx4 v[132:135], v52, s[28:31], s76 offen sc1
L_nobg:
  s_barrier
  s_mov_b32 s83, 65536
L_og:
  buffer_load_dwordx4 v[60:63], v3, s[28:31], s94 offen offset:0 sc1
  buffer_load_dwordx4 v[64:67], v3, s[28:31], s94 offen offset:1024 sc1
  s_mov_b64 exec, -1
  s_waitcnt vmcnt(0)
  v_min3_u32 v84, v63, v67, s3
  v_max3_u32 v85, v63, v67, s3
  v_cmp_ne_u32 vcc, v84, v85
  s_nop 0
  s_cbranch_vccz L_ogok
  s_sub_u32 s83, s83, 1
  s_cmp_gt_i32 s83, 0
  s_cbranch_scc0 L_ogok
  s_mov_b64 exec, vcc
  s_branch L_og
L_ogok:
  v_mul_f32_dpp v76, v62, v54 quad_perm:[0,0,0,0] row_mask:0xf bank_mask:0xf
  v_mul_f32_dpp v77, v66, v54 quad_perm:[0,0,0,0] row_mask:0xf bank_mask:0xf
  v_max_f32 v80, v76, v77
  s_nop 1
  v_max_f32_dpp v80, v80, v80 row_ror:4 row_mask:0xf bank_mask:0xf
  s_nop 1
  v_max_f32_dpp v80, v80, v80 row_ror:8 row_mask:0xf bank_mask:0xf
  v_mov_b32 v84, v80
  s_nop 1
  v_permlane32_swap_b32 v80, v84
  v_max_f32 v80, v80, v84
  v_mov_b32 v84, v80
  s_nop 1
  v_permlane16_swap_b32 v80, v84
  v_max_f32 v80, v80, v84
  v_sub_f32 v76, v76, v80
  v_sub_f32 v77, v77, v80
  v_exp_f32 v76, v76
  v_exp_f32 v77, v77
  v_mul_f32 v81, v76, v60
  v_mul_f32 v82, v76, v61
  v_mul_f32 v83, v76, v62
  v_fmac_f32 v81, v77, v64
  v_fmac_f32 v82, v77, v65
  v_fmac_f32 v83, v77, v66
  v_add_f32_dpp v81, v81, v81 row_ror:4 row_mask:0xf bank_mask:0xf
  v_add_f32_dpp v82, v82, v82 row_ror:4 row_mask:0xf bank_mask:0xf
  v_add_f32_dpp v83, v83, v83 row_ror:4 row_mask:0xf bank_mask:0xf
  v_add_f32_dpp v81, v81, v81 row_ror:8 row_mask:0xf bank_mask:0xf
  v_add_f32_dpp v82, v82, v82 row_ror:8 row_mask:0xf bank_mask:0xf
  v_add_f32_dpp v83, v83, v83 row_ror:8 row_mask:0xf bank_mask:0xf
  v_mov_b32 v84, v83
  v_permlane32_swap_b32 v81, v82
  s_nop 0
  v_permlane32_swap_b32 v83, v84
  v_add_f32 v81, v81, v82
  v_add_f32 v83, v83, v84
  s_nop 1
  v_permlane16_swap_b32 v81, v83
  v_add_f32 v81, v81, v83
  s_nop 0
  v_readlane_b32 s75, v81, 17
  s_nop 1
  v_rcp_f32 v85, s75
  s_nop 0
  v_mul_f32 v81, v81, v85
  v_mov_b32 v84, v81
  s_nop 1
  v_permlane32_swap_b32 v81, v84
  v_cvt_pk_bf16_f32 v81, v81, v84
  s_nop 0
  v_readlane_b32 s90, v81, 0
  v_readlane_b32 s91, v81, 1
  v_readlane_b32 s92, v81, 2
  v_readlane_b32 s93, v81, 3
  v_dot2_f32_bf16 v88, s90, v48, 0
  v_dot2_f32_bf16 v89, s90, v20, 0
  v_dot2_f32_bf16 v90, s90, v16, 0
  v_dot2_f32_bf16 v92, s90, v21, 0
  v_dot2_f32_bf16 v93, s90, v17, 0
  v_dot2_f32_bf16 v94, s90, v22, 0
  v_dot2_f32_bf16 v96, s90, v18, 0
  v_dot2_f32_bf16 v97, s90, v23, 0
  v_dot2c_f32_bf16 v88, s91, v19
  v_dot2c_f32_bf16 v89, s91, v28
  v_dot2c_f32_bf16 v90, s91, v24
  v_dot2c_f32_bf16 v92, s91, v29
  v_dot2c_f32_bf16 v93, s91, v25
  v_dot2c_f32_bf16 v94, s91, v30
  v_dot2c_f32_bf16 v96, s91, v26
  v_dot2c_f32_bf16 v97, s91, v31
  v_dot2c_f32_bf16 v88, s92, v27
  v_dot2c_f32_bf16 v89, s92, v36
  v_dot2c_f32_bf16 v90, s92, v32
  v_dot2c_f32_bf16 v92, s92, v37
  v_dot2c_f32_bf16 v93, s92, v33
  v_dot2c_f32_bf16 v94, s92, v38
  v_dot2c_f32_bf16 v96, s92, v34
  v_dot2c_f32_bf16 v97, s92, v39
  v_dot2c_f32_bf16 v88, s93, v35
  v_dot2c_f32_bf16 v89, s93, v44
  v_dot2c_f32_bf16 v90, s93, v40
  v_dot2c_f32_bf16 v92, s93, v45
  v_dot2c_f32_bf16 v93, s93, v41
  v_dot2c_f32_bf16 v94, s93, v46
  v_dot2c_f32_bf16 v96, s93, v42
  v_dot2c_f32_bf16 v97, s93, v47
  s_mov_b32 exec_hi, 0xff
  ds_write_b128 v50, v[88:91] offset:3072
  ds_write_b128 v50, v[92:95] offset:3088
  ds_write_b128 v50, v[96:99] offset:3104
  s_mov_b64 exec, -1
  s_waitcnt lgkmcnt(0)
  s_barrier
  s_cmp_eq_u32 s70, 3
  s_cselect_b32 s77, 0x00ffffff, -1
  s_mov_b32 exec_lo, s77
  s_mov_b32 exec_hi, 0
  ds_read_b128 v[100:103], v51 offset:3072
  ds_read_b128 v[104:107], v51 offset:4992
  ds_read_b128 v[108:111], v51 offset:6912
  ds_read_b128 v[112:115], v51 offset:8832
  s_waitcnt lgkmcnt(2)
  v_pk_add_f32 v[100:101], v[100:101], v[104:105]
  v_add_f32 v102, v102, v106
  s_waitcnt lgkmcnt(0)
  v_pk_add_f32 v[108:109], v[108:109], v[112:113]
  v_add_f32 v110, v110, v114
  v_pk_add_f32 v[116:117], v[100:101], v[108:109]
  v_add_f32 v118, v102, v110
  buffer_store_dwordx4 v[116:119], v3, s[28:31], s79 offen sc1
  s_mov_b64 exec, -1
  s_cmp_lt_u32 s80, 4
  s_cbranch_scc0 L_fin
  buffer_load_dwordx4 v[120:123], v52, s[28:31], s54 offen sc1
  buffer_load_dwordx4 v[124:127], v52, s[28:31], s55 offen sc1
  v_min3_u32 v84, v131, v135, s3
  v_max3_u32 v85, v131, v135, s3
  v_cmp_ne_u32 vcc, v84, v85
  s_nop 0
  s_cbranch_vccnz L_bslow
L_bok:
  v_pk_add_f32 v[128:129], v[128:129], v[132:133]
  v_add_f32 v130, v130, v134
  v_mov_b32 v84, v130
  v_permlane32_swap_b32 v128, v129
  s_nop 0
  v_permlane32_swap_b32 v130, v84
  v_add_f32 v128, v128, v129
  v_add_f32 v130, v130, v84
  s_nop 1
  v_permlane16_swap_b32 v128, v130
  v_add_f32 v128, v128, v130
  s_nop 1
  v_add_f32_dpp v128, v128, v128 row_ror:8 row_mask:0xf bank_mask:0xf
  s_nop 1
  v_add_f32_dpp v128, v128, v128 row_ror:4 row_mask:0xf bank_mask:0xf
  s_nop 1
  v_add_f32_dpp v128, v128, v128 row_ror:2 row_mask:0xf bank_mask:0xf
  s_nop 1
  v_add_f32_dpp v57, v128, v128 row_ror:1 row_mask:0xf bank_mask:0xf
  v_cvt_pk_bf16_f32 v57, v57, v57
  v_lshlrev_b32 v57, 16, v57
  v_lshlrev_b32 v56, 16, v56
  v_add_f32 v57, v57, v56
  v_cvt_pk_bf16_f32 v57, v57, v57
  v_lshlrev_b32 v57, 16, v57
  v_lshlrev_b32 v55, 16, v55
  s_mov_b32 s83, 65536
L_fg:
  s_waitcnt vmcnt(0)
  v_min3_u32 v84, v123, v127, s3
  v_max3_u32 v85, v123, v127, s3
  v_cmp_ne_u32 vcc, v84, v85
  s_nop 0
  s_cbranch_vccz L_fgok
  s_sub_u32 s83, s83, 1
  s_cmp_gt_i32 s83, 0
  s_cbranch_scc0 L_fgok
  s_mov_b64 exec, vcc
  buffer_load_dwordx4 v[120:123], v52, s[28:31], s54 offen sc1
  buffer_load_dwordx4 v[124:127], v52, s[28:31], s55 offen sc1
  s_mov_b64 exec, -1
  s_branch L_fg
L_fgok:
  v_pk_add_f32 v[120:121], v[120:121], v[124:125]
  v_add_f32 v122, v122, v126
  v_mov_b32 v84, v122
  v_permlane32_swap_b32 v120, v121
  s_nop 0
  v_permlane32_swap_b32 v122, v84
  v_add_f32 v120, v120, v121
  v_add_f32 v122, v122, v84
  s_nop 1
  v_permlane16_swap_b32 v120, v122
  v_add_f32 v120, v120, v122
  s_nop 1
  v_add_f32_dpp v120, v120, v120 row_ror:8 row_mask:0xf bank_mask:0xf
  s_nop 1
  v_add_f32_dpp v120, v120, v120 row_ror:4 row_mask:0xf bank_mask:0xf
  s_nop 1
  v_add_f32_dpp v120, v120, v120 row_ror:2 row_mask:0xf bank_mask:0xf
  s_nop 1
  v_add_f32_dpp v81, v120, v120 row_ror:1 row_mask:0xf bank_mask:0xf
  v_cvt_pk_bf16_f32 v81, v81, v81
  v_lshlrev_b32 v81, 16, v81
  v_add_f32 v81, v55, v81
  v_cvt_pk_bf16_f32 v81, v81, v81
  v_lshlrev_b32 v81, 16, v81
  v_add_f32 v81, v81, v57
  v_cvt_pk_bf16_f32 v81, v81, v81
  s_cmp_lt_u32 s80, 2
  s_cselect_b32 s75, 0x10001, 1
  s_mov_b32 exec_lo, s75
  s_mov_b32 exec_hi, 1
  buffer_store_short v81, v53, s[40:43], 0 offen
  s_cmp_eq_u32 s2, 0
  s_cbranch_scc0 L_noep
  v_mov_b32 v82, s3
  s_mov_b32 s75, 0
  s_mov_b64 exec, 1
  buffer_store_dword v82, off, s[28:31], s75
L_noep:
  s_mov_b64 exec, -1
L_fin:
L_end:
  s_endpgm
L_bslow:
  s_add_u32 s75, s54, 491520
  s_add_u32 s76, s55, 491520
  s_mov_b32 s83, 65536
L_bg:
  s_mov_b64 exec, vcc
  buffer_load_dwordx4 v[128:131], v52, s[28:31], s75 offen sc1
  buffer_load_dwordx4 v[132:135], v52, s[28:31], s76 offen sc1
  s_mov_b64 exec, -1
  s_waitcnt vmcnt(0)
  v_min3_u32 v84, v131, v135, s3
  v_max3_u32 v85, v131, v135, s3
  v_cmp_ne_u32 vcc, v84, v85
  s_nop 0
  s_cbranch_vccz L_bok
  s_sub_u32 s83, s83, 1
  s_cmp_gt_i32 s83, 0
  s_cbranch_scc1 L_bg
  s_branch L_bok
.section .rodata,"a"
.p2align 6
.amdhsa_kernel parallel_sum__gqa_block_cached__mixer_channel_mlp__decode_kernel
  .amdhsa_next_free_vgpr 256
  .amdhsa_next_free_sgpr 102
  .amdhsa_accum_offset 256
  .amdhsa_group_segment_fixed_size 0
  .amdhsa_kernarg_size 104
  .amdhsa_user_sgpr_count 2
  .amdhsa_user_sgpr_kernarg_segment_ptr 1
  .amdhsa_system_sgpr_workgroup_id_x 1
.end_amdhsa_kernel
```
